```python
import torch

def _softmax(x, axis=-1):
    return torch.softmax(x, dim=axis)
def _gelu(x):
    return torch.nn.functional.gelu(x, approximate="tanh")
def _silu(x):
    return torch.nn.functional.silu(x)
def _sigmoid(x):
    return torch.sigmoid(x)
def _layernorm(x, axis=-1, eps=1e-5):
    m = x.mean(dim=axis, keepdim=True)
    v = x.var(dim=axis, keepdim=True, unbiased=False)
    return (x - m) / torch.sqrt(v + eps)
def _scatter_add(tgt, idx, src, axis=0):
    return tgt.clone().index_add_(axis, idx, src)
def _segment_sum(src, seg, n):
    out = torch.zeros((n,) + src.shape[1:], dtype=src.dtype)
    return out.index_add_(0, seg, src)
def _pad(x, pw):
    flat = tuple(v for pair in reversed(pw) for v in pair)
    return torch.nn.functional.pad(x, flat)

kernel_name = 'sequential_preLN__sliding_block_cached__glu_gated_bilinear__decode'

def setup_inputs():

    _w = (lambda a: (lambda t: t.to(torch.bfloat16) if t.is_floating_point() else t)(torch.as_tensor(a)))
    def _A_setup():
        B, Sq, D = 4, 1, 512
        Hq, Hkv, Sk, Dh = 32, 32, 4096, 128
        assert Hq % Hkv == 0, (Hq, Hkv)
        return {
            "x": _w((lambda *s: torch.randn(*s, dtype=torch.bfloat16) * 0.05)(B, Sq, D)),
            "k_cache": _w((lambda *s: torch.randn(*s, dtype=torch.bfloat16) * 1.6)(B, Hkv, Sk, Dh)),
            "v_cache": _w((lambda *s: torch.randn(*s, dtype=torch.bfloat16) * 0.8)(B, Hkv, Sk, Dh)),
            "wq": _w((lambda *s: torch.randn(*s, dtype=torch.bfloat16) * 1.6)(D, Hq * Dh) * (D ** -0.5)),
            "wo": _w((lambda *s: torch.randn(*s, dtype=torch.bfloat16) * 0.8)(Hq * Dh, D) * ((Hq * Dh) ** -0.5)),
        }
    _A_in = _A_setup()

    def _B_setup():
        B, S, D, F = 4, 1, 512, 1376
        return {
            "x": _w((lambda *s: torch.randn(*s, dtype=torch.bfloat16) * 0.05)(B, S, D)),
            "w_gate": _w((lambda *s: torch.randn(*s, dtype=torch.bfloat16) * 0.4)(D, F) * (D ** -0.5)),
            "w_up": _w((lambda *s: torch.randn(*s, dtype=torch.bfloat16) * 0.4)(D, F) * (D ** -0.5)),
            "w_down": _w((lambda *s: torch.randn(*s, dtype=torch.bfloat16) * 0.4)(F, D) * (F ** -0.5)),
        }
    _B_in = _B_setup()

    return {
        "A_x": _A_in["x"],
        "A_k_cache": _A_in["k_cache"],
        "A_v_cache": _A_in["v_cache"],
        "A_wq": _A_in["wq"],
        "A_wo": _A_in["wo"],
        "B_x": _B_in["x"],
        "B_w_gate": _B_in["w_gate"],
        "B_w_up": _B_in["w_up"],
        "B_w_down": _B_in["w_down"],
    }

def reference(A_x, A_k_cache, A_v_cache, A_wq, A_wo, B_x, B_w_gate, B_w_up, B_w_down):
    def _A_ref(x, k_cache, v_cache, wq, wo):
        B, Sq, D = x.shape
        Hq, Dh = 32, 128
        Hkv, Sk = k_cache.shape[1], k_cache.shape[2]
        W = min(4096, max(256, Sk // 4))
        rep = Hq // Hkv
        q = (lambda x, *d: x.permute(*d))((x @ wq).reshape(B, Sq, Hq, Dh), 0, 2, 1, 3)
        k = (lambda x, n, axis: torch.repeat_interleave(x, n, dim=axis))(k_cache[:, :, Sk - W:, :], rep, axis=1)
        v = (lambda x, n, axis: torch.repeat_interleave(x, n, dim=axis))(v_cache[:, :, Sk - W:, :], rep, axis=1)
        scores = torch.einsum("bhqd,bhkd->bhqk", q, k) * (Dh ** -0.5)
        p = _softmax(scores, axis=-1)
        o = torch.einsum("bhqk,bhkd->bhqd", p, v)
        return (lambda x, *d: x.permute(*d))(o, 0, 2, 1, 3).reshape(B, Sq, Hq * Dh) @ wo

    def _B_ref(x, w_gate, w_up, w_down):
        g = torch.einsum("bsd,df->bsf", x, w_gate)
        u = torch.einsum("bsd,df->bsf", x, w_up)
        h = g * u
        return torch.einsum("bsf,fd->bsd", h, w_down)

    x = A_x
    h = x + _A_ref(_layernorm(x, axis=-1), A_k_cache, A_v_cache, A_wq, A_wo)
    h2 = h + _B_ref(_layernorm(h, axis=-1), B_w_gate, B_w_up, B_w_down)
    return h2
```

```asm
; @launch grid=(256,1,1) block=(768,1,1) lds=8192
.amdgcn_target "amdgcn-amd-amdhsa--gfx950"
.text
.globl sequential_preLN__sliding_block_cached__glu_gated_bilinear__decode_kernel
.p2align 8
.type sequential_preLN__sliding_block_cached__glu_gated_bilinear__decode_kernel,@function
sequential_preLN__sliding_block_cached__glu_gated_bilinear__decode_kernel:
  s_cmp_ge_u32 s2, 0x100
  s_cbranch_scc1 L_END
  s_load_dwordx16 s[4:19], s[0:1], 0
  s_load_dwordx8 s[20:27], s[0:1], 64
  v_lshrrev_b32 v1, 6, v0
  v_and_b32 v0, 63, v0
  v_readfirstlane_b32 s3, v1
  s_and_b32 s61, s2, 7
  s_lshr_b32 s60, s2, 3
  s_lshr_b32 s28, s60, 3
  s_lshl_b32 s56, s61, 2
  s_add_u32 s28, s28, s56
  s_and_b32 s29, s60, 7
  s_lshr_b32 s30, s29, 1
  s_and_b32 s31, s29, 1
  s_mov_b32 s66, 0x05040100
  s_mov_b32 s67, 0x07060302
  s_mov_b32 s68, 0x3F803F80
  s_cmp_ge_u32 s3, 8
  s_cbranch_scc1 L_HELP
  s_cmp_ge_u32 s3, 4
  s_cbranch_scc1 L_VSIDE
  s_waitcnt lgkmcnt(0)
  s_lshl_b32 s56, s30, 5
  s_add_u32 s56, s56, s28
  s_lshl_b32 s56, s56, 20
  s_lshl_b32 s57, s31, 17
  s_add_u32 s56, s56, s57
  s_add_u32 s56, s56, 0xC0000
  s_add_u32 s40, s6, s56
  s_addc_u32 s41, s7, 0
  s_mov_b32 s42, 0x20000
  s_mov_b32 s43, 0x00020000
  s_and_b32 s59, s3, 3
  s_lshl_b32 s59, s59, 10
  v_lshlrev_b32 v1, 4, v0
  v_add_u32 v1, s59, v1
  s_mov_b32 s57, 0
  s_barrier
  buffer_load_dwordx4 v[40:43], v1, s[40:43], s57 offen nt
  s_add_u32 s57, s57, 0x1000
  s_and_b32 s57, s57, 0x1F000
  buffer_load_dwordx4 v[104:107], v1, s[40:43], s57 offen nt
  s_add_u32 s57, s57, 0x1000
  s_and_b32 s57, s57, 0x1F000
  buffer_load_dwordx4 v[44:47], v1, s[40:43], s57 offen nt
  s_add_u32 s57, s57, 0x1000
  s_and_b32 s57, s57, 0x1F000
  buffer_load_dwordx4 v[108:111], v1, s[40:43], s57 offen nt
  s_add_u32 s57, s57, 0x1000
  s_and_b32 s57, s57, 0x1F000
  buffer_load_dwordx4 v[48:51], v1, s[40:43], s57 offen nt
  s_add_u32 s57, s57, 0x1000
  s_and_b32 s57, s57, 0x1F000
  buffer_load_dwordx4 v[112:115], v1, s[40:43], s57 offen nt
  s_add_u32 s57, s57, 0x1000
  s_and_b32 s57, s57, 0x1F000
  buffer_load_dwordx4 v[52:55], v1, s[40:43], s57 offen nt
  s_add_u32 s57, s57, 0x1000
  s_and_b32 s57, s57, 0x1F000
  buffer_load_dwordx4 v[116:119], v1, s[40:43], s57 offen nt
  s_add_u32 s57, s57, 0x1000
  s_and_b32 s57, s57, 0x1F000
  buffer_load_dwordx4 v[56:59], v1, s[40:43], s57 offen nt
  s_add_u32 s57, s57, 0x1000
  s_and_b32 s57, s57, 0x1F000
  buffer_load_dwordx4 v[120:123], v1, s[40:43], s57 offen nt
  s_add_u32 s57, s57, 0x1000
  s_and_b32 s57, s57, 0x1F000
  buffer_load_dwordx4 v[60:63], v1, s[40:43], s57 offen nt
  s_add_u32 s57, s57, 0x1000
  s_and_b32 s57, s57, 0x1F000
  buffer_load_dwordx4 v[124:127], v1, s[40:43], s57 offen nt
  s_add_u32 s57, s57, 0x1000
  s_and_b32 s57, s57, 0x1F000
  buffer_load_dwordx4 v[64:67], v1, s[40:43], s57 offen nt
  s_add_u32 s57, s57, 0x1000
  s_and_b32 s57, s57, 0x1F000
  buffer_load_dwordx4 v[128:131], v1, s[40:43], s57 offen nt
  s_add_u32 s57, s57, 0x1000
  s_and_b32 s57, s57, 0x1F000
  buffer_load_dwordx4 v[68:71], v1, s[40:43], s57 offen nt
  s_add_u32 s57, s57, 0x1000
  s_and_b32 s57, s57, 0x1F000
  buffer_load_dwordx4 v[132:135], v1, s[40:43], s57 offen nt
  s_add_u32 s57, s57, 0x1000
  s_and_b32 s57, s57, 0x1F000
  buffer_load_dwordx4 v[72:75], v1, s[40:43], s57 offen nt
  s_add_u32 s57, s57, 0x1000
  s_and_b32 s57, s57, 0x1F000
  buffer_load_dwordx4 v[136:139], v1, s[40:43], s57 offen nt
  s_add_u32 s57, s57, 0x1000
  s_and_b32 s57, s57, 0x1F000
  buffer_load_dwordx4 v[76:79], v1, s[40:43], s57 offen nt
  s_add_u32 s57, s57, 0x1000
  s_and_b32 s57, s57, 0x1F000
  buffer_load_dwordx4 v[140:143], v1, s[40:43], s57 offen nt
  s_add_u32 s57, s57, 0x1000
  s_and_b32 s57, s57, 0x1F000
  buffer_load_dwordx4 v[80:83], v1, s[40:43], s57 offen nt
  s_add_u32 s57, s57, 0x1000
  s_and_b32 s57, s57, 0x1F000
  buffer_load_dwordx4 v[144:147], v1, s[40:43], s57 offen nt
  s_add_u32 s57, s57, 0x1000
  s_and_b32 s57, s57, 0x1F000
  buffer_load_dwordx4 v[84:87], v1, s[40:43], s57 offen nt
  s_add_u32 s57, s57, 0x1000
  s_and_b32 s57, s57, 0x1F000
  buffer_load_dwordx4 v[148:151], v1, s[40:43], s57 offen nt
  s_add_u32 s57, s57, 0x1000
  s_and_b32 s57, s57, 0x1F000
  buffer_load_dwordx4 v[88:91], v1, s[40:43], s57 offen nt
  s_add_u32 s57, s57, 0x1000
  s_and_b32 s57, s57, 0x1F000
  buffer_load_dwordx4 v[152:155], v1, s[40:43], s57 offen nt
  s_add_u32 s57, s57, 0x1000
  s_and_b32 s57, s57, 0x1F000
  buffer_load_dwordx4 v[92:95], v1, s[40:43], s57 offen nt
  s_add_u32 s57, s57, 0x1000
  s_and_b32 s57, s57, 0x1F000
  buffer_load_dwordx4 v[156:159], v1, s[40:43], s57 offen nt
  s_add_u32 s57, s57, 0x1000
  s_and_b32 s57, s57, 0x1F000
  buffer_load_dwordx4 v[96:99], v1, s[40:43], s57 offen nt
  s_add_u32 s57, s57, 0x1000
  s_and_b32 s57, s57, 0x1F000
  buffer_load_dwordx4 v[160:163], v1, s[40:43], s57 offen nt
  s_add_u32 s57, s57, 0x1000
  s_and_b32 s57, s57, 0x1F000
  buffer_load_dwordx4 v[100:103], v1, s[40:43], s57 offen nt
  s_add_u32 s57, s57, 0x1000
  s_and_b32 s57, s57, 0x1F000
  buffer_load_dwordx4 v[164:167], v1, s[40:43], s57 offen nt
  v_mov_b32 v4, 0
  v_mov_b32 v6, 1
  s_mov_b64 exec, 1
  ds_add_u32 v4, v6 offset:16
  s_mov_b64 exec, -1
  v_lshrrev_b32 v2, 4, v0
  v_and_b32 v3, 15, v0
  v_lshlrev_b32 v5, 4, v3
  s_mov_b32 s62, 0xAAAAAAAA
  s_mov_b32 s63, 0xAAAAAAAA
  s_mov_b32 s64, 0xCCCCCCCC
  s_mov_b32 s65, 0xCCCCCCCC
  s_mov_b32 s58, 200000
L_lw_1:
  ds_read_b32 v6, v4 offset:0
  ds_read_b128 v[8:11], v5 offset:256
  s_waitcnt lgkmcnt(0)
  v_readfirstlane_b32 s56, v6
  s_cmp_eq_u32 s56, 1
  s_cbranch_scc1 L_lwd_2
  s_sub_u32 s58, s58, 1
  s_cbranch_scc0 L_lw_1
L_lwd_2:
  s_waitcnt vmcnt(31)
  v_dot2_f32_bf16 v40, v40, v8, 0
  v_dot2_f32_bf16 v40, v41, v9, v40
  v_dot2_f32_bf16 v40, v42, v10, v40
  v_dot2_f32_bf16 v40, v43, v11, v40
  s_waitcnt vmcnt(29)
  v_dot2_f32_bf16 v44, v44, v8, 0
  v_dot2_f32_bf16 v44, v45, v9, v44
  v_dot2_f32_bf16 v44, v46, v10, v44
  v_dot2_f32_bf16 v44, v47, v11, v44
  s_waitcnt vmcnt(27)
  v_dot2_f32_bf16 v48, v48, v8, 0
  v_dot2_f32_bf16 v48, v49, v9, v48
  v_dot2_f32_bf16 v48, v50, v10, v48
  v_dot2_f32_bf16 v48, v51, v11, v48
  s_waitcnt vmcnt(25)
  v_dot2_f32_bf16 v52, v52, v8, 0
  v_dot2_f32_bf16 v52, v53, v9, v52
  v_dot2_f32_bf16 v52, v54, v10, v52
  v_dot2_f32_bf16 v52, v55, v11, v52
  s_waitcnt vmcnt(23)
  v_dot2_f32_bf16 v56, v56, v8, 0
  v_dot2_f32_bf16 v56, v57, v9, v56
  v_dot2_f32_bf16 v56, v58, v10, v56
  v_dot2_f32_bf16 v56, v59, v11, v56
  s_waitcnt vmcnt(21)
  v_dot2_f32_bf16 v60, v60, v8, 0
  v_dot2_f32_bf16 v60, v61, v9, v60
  v_dot2_f32_bf16 v60, v62, v10, v60
  v_dot2_f32_bf16 v60, v63, v11, v60
  s_waitcnt vmcnt(19)
  v_dot2_f32_bf16 v64, v64, v8, 0
  v_dot2_f32_bf16 v64, v65, v9, v64
  v_dot2_f32_bf16 v64, v66, v10, v64
  v_dot2_f32_bf16 v64, v67, v11, v64
  s_waitcnt vmcnt(17)
  v_dot2_f32_bf16 v68, v68, v8, 0
  v_dot2_f32_bf16 v68, v69, v9, v68
  v_dot2_f32_bf16 v68, v70, v10, v68
  v_dot2_f32_bf16 v68, v71, v11, v68
  s_waitcnt vmcnt(15)
  v_dot2_f32_bf16 v72, v72, v8, 0
  v_dot2_f32_bf16 v72, v73, v9, v72
  v_dot2_f32_bf16 v72, v74, v10, v72
  v_dot2_f32_bf16 v72, v75, v11, v72
  s_waitcnt vmcnt(13)
  v_dot2_f32_bf16 v76, v76, v8, 0
  v_dot2_f32_bf16 v76, v77, v9, v76
  v_dot2_f32_bf16 v76, v78, v10, v76
  v_dot2_f32_bf16 v76, v79, v11, v76
  s_waitcnt vmcnt(11)
  v_dot2_f32_bf16 v80, v80, v8, 0
  v_dot2_f32_bf16 v80, v81, v9, v80
  v_dot2_f32_bf16 v80, v82, v10, v80
  v_dot2_f32_bf16 v80, v83, v11, v80
  s_waitcnt vmcnt(9)
  v_dot2_f32_bf16 v84, v84, v8, 0
  v_dot2_f32_bf16 v84, v85, v9, v84
  v_dot2_f32_bf16 v84, v86, v10, v84
  v_dot2_f32_bf16 v84, v87, v11, v84
  s_waitcnt vmcnt(7)
  v_dot2_f32_bf16 v88, v88, v8, 0
  v_dot2_f32_bf16 v88, v89, v9, v88
  v_dot2_f32_bf16 v88, v90, v10, v88
  v_dot2_f32_bf16 v88, v91, v11, v88
  s_waitcnt vmcnt(5)
  v_dot2_f32_bf16 v92, v92, v8, 0
  v_dot2_f32_bf16 v92, v93, v9, v92
  v_dot2_f32_bf16 v92, v94, v10, v92
  v_dot2_f32_bf16 v92, v95, v11, v92
  s_waitcnt vmcnt(3)
  v_dot2_f32_bf16 v96, v96, v8, 0
  v_dot2_f32_bf16 v96, v97, v9, v96
  v_dot2_f32_bf16 v96, v98, v10, v96
  v_dot2_f32_bf16 v96, v99, v11, v96
  s_waitcnt vmcnt(1)
  v_dot2_f32_bf16 v100, v100, v8, 0
  v_dot2_f32_bf16 v100, v101, v9, v100
  v_dot2_f32_bf16 v100, v102, v10, v100
  v_dot2_f32_bf16 v100, v103, v11, v100
  v_add_f32_dpp v40, v40, v40 row_ror:8 row_mask:0xf bank_mask:0x3
  v_add_f32_dpp v44, v44, v44 row_ror:8 row_mask:0xf bank_mask:0x3
  v_add_f32_dpp v48, v48, v48 row_ror:8 row_mask:0xf bank_mask:0x3
  v_add_f32_dpp v52, v52, v52 row_ror:8 row_mask:0xf bank_mask:0x3
  v_add_f32_dpp v56, v56, v56 row_ror:8 row_mask:0xf bank_mask:0x3
  v_add_f32_dpp v60, v60, v60 row_ror:8 row_mask:0xf bank_mask:0x3
  v_add_f32_dpp v64, v64, v64 row_ror:8 row_mask:0xf bank_mask:0x3
  v_add_f32_dpp v68, v68, v68 row_ror:8 row_mask:0xf bank_mask:0x3
  v_add_f32_dpp v40, v72, v72 row_ror:8 row_mask:0xf bank_mask:0xc
  v_add_f32_dpp v44, v76, v76 row_ror:8 row_mask:0xf bank_mask:0xc
  v_add_f32_dpp v48, v80, v80 row_ror:8 row_mask:0xf bank_mask:0xc
  v_add_f32_dpp v52, v84, v84 row_ror:8 row_mask:0xf bank_mask:0xc
  v_add_f32_dpp v56, v88, v88 row_ror:8 row_mask:0xf bank_mask:0xc
  v_add_f32_dpp v60, v92, v92 row_ror:8 row_mask:0xf bank_mask:0xc
  v_add_f32_dpp v64, v96, v96 row_ror:8 row_mask:0xf bank_mask:0xc
  v_add_f32_dpp v68, v100, v100 row_ror:8 row_mask:0xf bank_mask:0xc
  v_add_f32_dpp v40, v40, v40 row_half_mirror row_mask:0xf bank_mask:0x5
  v_add_f32_dpp v44, v44, v44 row_half_mirror row_mask:0xf bank_mask:0x5
  v_add_f32_dpp v48, v48, v48 row_half_mirror row_mask:0xf bank_mask:0x5
  v_add_f32_dpp v52, v52, v52 row_half_mirror row_mask:0xf bank_mask:0x5
  v_add_f32_dpp v40, v56, v56 row_half_mirror row_mask:0xf bank_mask:0xa
  v_add_f32_dpp v44, v60, v60 row_half_mirror row_mask:0xf bank_mask:0xa
  v_add_f32_dpp v48, v64, v64 row_half_mirror row_mask:0xf bank_mask:0xa
  v_add_f32_dpp v52, v68, v68 row_half_mirror row_mask:0xf bank_mask:0xa
  v_add_f32_dpp v40, v40, v40 quad_perm:[1,0,3,2] row_mask:0xf bank_mask:0xf
  v_add_f32_dpp v44, v44, v44 quad_perm:[1,0,3,2] row_mask:0xf bank_mask:0xf
  v_add_f32_dpp v48, v48, v48 quad_perm:[1,0,3,2] row_mask:0xf bank_mask:0xf
  v_add_f32_dpp v52, v52, v52 quad_perm:[1,0,3,2] row_mask:0xf bank_mask:0xf
  v_add_f32_dpp v40, v40, v40 quad_perm:[2,3,0,1] row_mask:0xf bank_mask:0xf
  v_add_f32_dpp v44, v44, v44 quad_perm:[2,3,0,1] row_mask:0xf bank_mask:0xf
  v_add_f32_dpp v48, v48, v48 quad_perm:[2,3,0,1] row_mask:0xf bank_mask:0xf
  v_add_f32_dpp v52, v52, v52 quad_perm:[2,3,0,1] row_mask:0xf bank_mask:0xf
  v_cndmask_b32_e64 v40, v40, v44, s[62:63]
  v_cndmask_b32_e64 v48, v48, v52, s[62:63]
  v_cndmask_b32_e64 v12, v40, v48, s[64:65]
  s_waitcnt vmcnt(30)
  v_dot2_f32_bf16 v104, v104, v8, 0
  v_dot2_f32_bf16 v104, v105, v9, v104
  v_dot2_f32_bf16 v104, v106, v10, v104
  v_dot2_f32_bf16 v104, v107, v11, v104
  s_waitcnt vmcnt(28)
  v_dot2_f32_bf16 v108, v108, v8, 0
  v_dot2_f32_bf16 v108, v109, v9, v108
  v_dot2_f32_bf16 v108, v110, v10, v108
  v_dot2_f32_bf16 v108, v111, v11, v108
  s_waitcnt vmcnt(26)
  v_dot2_f32_bf16 v112, v112, v8, 0
  v_dot2_f32_bf16 v112, v113, v9, v112
  v_dot2_f32_bf16 v112, v114, v10, v112
  v_dot2_f32_bf16 v112, v115, v11, v112
  s_waitcnt vmcnt(24)
  v_dot2_f32_bf16 v116, v116, v8, 0
  v_dot2_f32_bf16 v116, v117, v9, v116
  v_dot2_f32_bf16 v116, v118, v10, v116
  v_dot2_f32_bf16 v116, v119, v11, v116
  s_waitcnt vmcnt(22)
  v_dot2_f32_bf16 v120, v120, v8, 0
  v_dot2_f32_bf16 v120, v121, v9, v120
  v_dot2_f32_bf16 v120, v122, v10, v120
  v_dot2_f32_bf16 v120, v123, v11, v120
  s_waitcnt vmcnt(20)
  v_dot2_f32_bf16 v124, v124, v8, 0
  v_dot2_f32_bf16 v124, v125, v9, v124
  v_dot2_f32_bf16 v124, v126, v10, v124
  v_dot2_f32_bf16 v124, v127, v11, v124
  s_waitcnt vmcnt(18)
  v_dot2_f32_bf16 v128, v128, v8, 0
  v_dot2_f32_bf16 v128, v129, v9, v128
  v_dot2_f32_bf16 v128, v130, v10, v128
  v_dot2_f32_bf16 v128, v131, v11, v128
  s_waitcnt vmcnt(16)
  v_dot2_f32_bf16 v132, v132, v8, 0
  v_dot2_f32_bf16 v132, v133, v9, v132
  v_dot2_f32_bf16 v132, v134, v10, v132
  v_dot2_f32_bf16 v132, v135, v11, v132
  s_waitcnt vmcnt(14)
  v_dot2_f32_bf16 v136, v136, v8, 0
  v_dot2_f32_bf16 v136, v137, v9, v136
  v_dot2_f32_bf16 v136, v138, v10, v136
  v_dot2_f32_bf16 v136, v139, v11, v136
  s_waitcnt vmcnt(12)
  v_dot2_f32_bf16 v140, v140, v8, 0
  v_dot2_f32_bf16 v140, v141, v9, v140
  v_dot2_f32_bf16 v140, v142, v10, v140
  v_dot2_f32_bf16 v140, v143, v11, v140
  s_waitcnt vmcnt(10)
  v_dot2_f32_bf16 v144, v144, v8, 0
  v_dot2_f32_bf16 v144, v145, v9, v144
  v_dot2_f32_bf16 v144, v146, v10, v144
  v_dot2_f32_bf16 v144, v147, v11, v144
  s_waitcnt vmcnt(8)
  v_dot2_f32_bf16 v148, v148, v8, 0
  v_dot2_f32_bf16 v148, v149, v9, v148
  v_dot2_f32_bf16 v148, v150, v10, v148
  v_dot2_f32_bf16 v148, v151, v11, v148
  s_waitcnt vmcnt(6)
  v_dot2_f32_bf16 v152, v152, v8, 0
  v_dot2_f32_bf16 v152, v153, v9, v152
  v_dot2_f32_bf16 v152, v154, v10, v152
  v_dot2_f32_bf16 v152, v155, v11, v152
  s_waitcnt vmcnt(4)
  v_dot2_f32_bf16 v156, v156, v8, 0
  v_dot2_f32_bf16 v156, v157, v9, v156
  v_dot2_f32_bf16 v156, v158, v10, v156
  v_dot2_f32_bf16 v156, v159, v11, v156
  s_waitcnt vmcnt(2)
  v_dot2_f32_bf16 v160, v160, v8, 0
  v_dot2_f32_bf16 v160, v161, v9, v160
  v_dot2_f32_bf16 v160, v162, v10, v160
  v_dot2_f32_bf16 v160, v163, v11, v160
  s_waitcnt vmcnt(0)
  v_dot2_f32_bf16 v164, v164, v8, 0
  v_dot2_f32_bf16 v164, v165, v9, v164
  v_dot2_f32_bf16 v164, v166, v10, v164
  v_dot2_f32_bf16 v164, v167, v11, v164
  v_add_f32_dpp v104, v104, v104 row_ror:8 row_mask:0xf bank_mask:0x3
  v_add_f32_dpp v108, v108, v108 row_ror:8 row_mask:0xf bank_mask:0x3
  v_add_f32_dpp v112, v112, v112 row_ror:8 row_mask:0xf bank_mask:0x3
  v_add_f32_dpp v116, v116, v116 row_ror:8 row_mask:0xf bank_mask:0x3
  v_add_f32_dpp v120, v120, v120 row_ror:8 row_mask:0xf bank_mask:0x3
  v_add_f32_dpp v124, v124, v124 row_ror:8 row_mask:0xf bank_mask:0x3
  v_add_f32_dpp v128, v128, v128 row_ror:8 row_mask:0xf bank_mask:0x3
  v_add_f32_dpp v132, v132, v132 row_ror:8 row_mask:0xf bank_mask:0x3
  v_add_f32_dpp v104, v136, v136 row_ror:8 row_mask:0xf bank_mask:0xc
  v_add_f32_dpp v108, v140, v140 row_ror:8 row_mask:0xf bank_mask:0xc
  v_add_f32_dpp v112, v144, v144 row_ror:8 row_mask:0xf bank_mask:0xc
  v_add_f32_dpp v116, v148, v148 row_ror:8 row_mask:0xf bank_mask:0xc
  v_add_f32_dpp v120, v152, v152 row_ror:8 row_mask:0xf bank_mask:0xc
  v_add_f32_dpp v124, v156, v156 row_ror:8 row_mask:0xf bank_mask:0xc
  v_add_f32_dpp v128, v160, v160 row_ror:8 row_mask:0xf bank_mask:0xc
  v_add_f32_dpp v132, v164, v164 row_ror:8 row_mask:0xf bank_mask:0xc
  v_add_f32_dpp v104, v104, v104 row_half_mirror row_mask:0xf bank_mask:0x5
  v_add_f32_dpp v108, v108, v108 row_half_mirror row_mask:0xf bank_mask:0x5
  v_add_f32_dpp v112, v112, v112 row_half_mirror row_mask:0xf bank_mask:0x5
  v_add_f32_dpp v116, v116, v116 row_half_mirror row_mask:0xf bank_mask:0x5
  v_add_f32_dpp v104, v120, v120 row_half_mirror row_mask:0xf bank_mask:0xa
  v_add_f32_dpp v108, v124, v124 row_half_mirror row_mask:0xf bank_mask:0xa
  v_add_f32_dpp v112, v128, v128 row_half_mirror row_mask:0xf bank_mask:0xa
  v_add_f32_dpp v116, v132, v132 row_half_mirror row_mask:0xf bank_mask:0xa
  v_add_f32_dpp v104, v104, v104 quad_perm:[1,0,3,2] row_mask:0xf bank_mask:0xf
  v_add_f32_dpp v108, v108, v108 quad_perm:[1,0,3,2] row_mask:0xf bank_mask:0xf
  v_add_f32_dpp v112, v112, v112 quad_perm:[1,0,3,2] row_mask:0xf bank_mask:0xf
  v_add_f32_dpp v116, v116, v116 quad_perm:[1,0,3,2] row_mask:0xf bank_mask:0xf
  v_add_f32_dpp v104, v104, v104 quad_perm:[2,3,0,1] row_mask:0xf bank_mask:0xf
  v_add_f32_dpp v108, v108, v108 quad_perm:[2,3,0,1] row_mask:0xf bank_mask:0xf
  v_add_f32_dpp v112, v112, v112 quad_perm:[2,3,0,1] row_mask:0xf bank_mask:0xf
  v_add_f32_dpp v116, v116, v116 quad_perm:[2,3,0,1] row_mask:0xf bank_mask:0xf
  v_cndmask_b32_e64 v104, v104, v108, s[62:63]
  v_cndmask_b32_e64 v112, v112, v116, s[62:63]
  v_cndmask_b32_e64 v13, v104, v112, s[64:65]
  v_cvt_pk_bf16_f32 v14, v12, v13
  v_lshlrev_b32 v12, 16, v14
  v_and_b32 v13, 0xffff0000, v14
  v_mul_f32 v12, 0x3DB504F3, v12
  v_mul_f32 v13, 0x3DB504F3, v13
  v_cvt_pk_bf16_f32 v14, v12, v13
  v_lshlrev_b32 v12, 16, v14
  v_and_b32 v13, 0xffff0000, v14
  v_max_f32 v14, v12, v13
  s_nop 1
  v_max_f32_dpp v14, v14, v14 row_ror:8 row_mask:0xf bank_mask:0xf
  s_nop 1
  v_max_f32_dpp v14, v14, v14 row_ror:4 row_mask:0xf bank_mask:0xf
  s_nop 1
  v_max_f32_dpp v14, v14, v14 row_ror:2 row_mask:0xf bank_mask:0xf
  s_nop 1
  v_max_f32_dpp v14, v14, v14 row_ror:1 row_mask:0xf bank_mask:0xf
  v_mov_b32 v15, v14
  s_nop 1
  v_permlane32_swap_b32 v14, v15
  v_max_f32 v14, v14, v15
  v_mov_b32 v15, v14
  s_nop 1
  v_permlane16_swap_b32 v14, v15
  v_max_f32 v14, v14, v15
  v_sub_f32 v12, v12, v14
  v_sub_f32 v13, v13, v14
  v_mul_f32 v12, 1069066811, v12
  v_mul_f32 v13, 1069066811, v13
  v_exp_f32 v12, v12
  v_exp_f32 v13, v13
  s_nop 0
  v_cvt_pk_bf16_f32 v16, v12, v13
  v_add_f32 v15, v12, v13
  s_mul_i32 s56, s3, 320
  v_mul_u32_u24 v17, 80, v2
  v_lshl_add_u32 v17, v3, 2, v17
  v_add_u32 v17, s56, v17
  ds_write_b32 v17, v16 offset:768
  v_add_f32_dpp v15, v15, v15 row_ror:8 row_mask:0xf bank_mask:0xf
  s_nop 1
  v_add_f32_dpp v15, v15, v15 row_ror:4 row_mask:0xf bank_mask:0xf
  s_nop 1
  v_add_f32_dpp v15, v15, v15 row_ror:2 row_mask:0xf bank_mask:0xf
  s_nop 1
  v_add_f32_dpp v15, v15, v15 row_ror:1 row_mask:0xf bank_mask:0xf
  v_mov_b32 v18, v15
  s_nop 1
  v_permlane32_swap_b32 v15, v18
  v_add_f32 v15, v15, v18
  v_mov_b32 v18, v15
  s_nop 1
  v_permlane16_swap_b32 v15, v18
  v_add_f32 v15, v15, v18
  s_lshl_b32 s56, s3, 3
  v_mov_b32 v17, s56
  s_mov_b64 exec, 1
  ds_write_b64 v17, v[14:15] offset:512
  s_mov_b64 exec, -1
  s_waitcnt lgkmcnt(0)
  s_barrier
  s_endpgm
L_VSIDE:
  s_waitcnt lgkmcnt(0)
  s_load_dword s39, s[26:27], 0
  s_lshl_b32 s56, s30, 5
  s_add_u32 s56, s56, s28
  s_lshl_b32 s56, s56, 20
  s_lshl_b32 s57, s31, 17
  s_add_u32 s56, s56, s57
  s_add_u32 s56, s56, 0xC0000
  s_add_u32 s40, s8, s56
  s_addc_u32 s41, s9, 0
  s_mov_b32 s42, 0x20000
  s_mov_b32 s43, 0x00020000
  s_and_b32 s59, s3, 3
  s_lshl_b32 s59, s59, 10
  v_lshlrev_b32 v1, 4, v0
  v_add_u32 v1, s59, v1
  s_mov_b32 s57, 0
  s_xor_b32 s59, s57, 0x10000
  s_barrier
  v_mov_b32 v2, 0
  v_mov_b32 v3, 1
  buffer_load_dwordx4 v[40:43], v1, s[40:43], s57 offen nt
  s_add_u32 s57, s57, 0x1000
  s_and_b32 s57, s57, 0x1F000
  buffer_load_dwordx4 v[44:47], v1, s[40:43], s57 offen nt
  s_add_u32 s57, s57, 0x1000
  s_and_b32 s57, s57, 0x1F000
  buffer_load_dwordx4 v[48:51], v1, s[40:43], s57 offen nt
  s_add_u32 s57, s57, 0x1000
  s_and_b32 s57, s57, 0x1F000
  buffer_load_dwordx4 v[52:55], v1, s[40:43], s57 offen nt
  s_add_u32 s57, s57, 0x1000
  s_and_b32 s57, s57, 0x1F000
  buffer_load_dwordx4 v[56:59], v1, s[40:43], s57 offen nt
  s_mov_b64 exec, 1
  ds_add_u32 v2, v3 offset:32
  s_mov_b64 exec, -1
  s_add_u32 s57, s57, 0x1000
  s_and_b32 s57, s57, 0x1F000
  buffer_load_dwordx4 v[60:63], v1, s[40:43], s57 offen nt
  s_add_u32 s57, s57, 0x1000
  s_and_b32 s57, s57, 0x1F000
  buffer_load_dwordx4 v[64:67], v1, s[40:43], s57 offen nt
  s_add_u32 s57, s57, 0x1000
  s_and_b32 s57, s57, 0x1F000
  buffer_load_dwordx4 v[68:71], v1, s[40:43], s57 offen nt
  s_add_u32 s57, s57, 0x1000
  s_and_b32 s57, s57, 0x1F000
  buffer_load_dwordx4 v[72:75], v1, s[40:43], s57 offen nt
  s_add_u32 s57, s57, 0x1000
  s_and_b32 s57, s57, 0x1F000
  buffer_load_dwordx4 v[76:79], v1, s[40:43], s57 offen nt
  s_add_u32 s57, s57, 0x1000
  s_and_b32 s57, s57, 0x1F000
  buffer_load_dwordx4 v[80:83], v1, s[40:43], s57 offen nt
  s_add_u32 s57, s57, 0x1000
  s_and_b32 s57, s57, 0x1F000
  buffer_load_dwordx4 v[84:87], v1, s[40:43], s57 offen nt
  s_add_u32 s57, s57, 0x1000
  s_and_b32 s57, s57, 0x1F000
  buffer_load_dwordx4 v[88:91], v1, s[40:43], s57 offen nt
  s_add_u32 s57, s57, 0x1000
  s_and_b32 s57, s57, 0x1F000
  buffer_load_dwordx4 v[92:95], v1, s[40:43], s57 offen nt
  s_add_u32 s57, s57, 0x1000
  s_and_b32 s57, s57, 0x1F000
  buffer_load_dwordx4 v[96:99], v1, s[40:43], s57 offen nt
  s_add_u32 s57, s57, 0x1000
  s_and_b32 s57, s57, 0x1F000
  buffer_load_dwordx4 v[100:103], v1, s[40:43], s57 offen nt
  s_add_u32 s57, s57, 0x1000
  s_and_b32 s57, s57, 0x1F000
  buffer_load_dwordx4 v[104:107], v1, s[40:43], s57 offen nt
  s_add_u32 s57, s57, 0x1000
  s_and_b32 s57, s57, 0x1F000
  buffer_load_dwordx4 v[108:111], v1, s[40:43], s57 offen nt
  s_add_u32 s57, s57, 0x1000
  s_and_b32 s57, s57, 0x1F000
  buffer_load_dwordx4 v[112:115], v1, s[40:43], s57 offen nt
  s_add_u32 s57, s57, 0x1000
  s_and_b32 s57, s57, 0x1F000
  buffer_load_dwordx4 v[116:119], v1, s[40:43], s57 offen nt
  s_add_u32 s57, s57, 0x1000
  s_and_b32 s57, s57, 0x1F000
  buffer_load_dwordx4 v[120:123], v1, s[40:43], s57 offen nt
  s_add_u32 s57, s57, 0x1000
  s_and_b32 s57, s57, 0x1F000
  buffer_load_dwordx4 v[124:127], v1, s[40:43], s57 offen nt
  s_add_u32 s57, s57, 0x1000
  s_and_b32 s57, s57, 0x1F000
  buffer_load_dwordx4 v[128:131], v1, s[40:43], s57 offen nt
  s_add_u32 s57, s57, 0x1000
  s_and_b32 s57, s57, 0x1F000
  buffer_load_dwordx4 v[132:135], v1, s[40:43], s57 offen nt
  s_add_u32 s57, s57, 0x1000
  s_and_b32 s57, s57, 0x1F000
  buffer_load_dwordx4 v[136:139], v1, s[40:43], s57 offen nt
  s_add_u32 s57, s57, 0x1000
  s_and_b32 s57, s57, 0x1F000
  buffer_load_dwordx4 v[140:143], v1, s[40:43], s57 offen nt
  s_add_u32 s57, s57, 0x1000
  s_and_b32 s57, s57, 0x1F000
  buffer_load_dwordx4 v[144:147], v1, s[40:43], s57 offen nt
  s_add_u32 s57, s57, 0x1000
  s_and_b32 s57, s57, 0x1F000
  buffer_load_dwordx4 v[148:151], v1, s[40:43], s57 offen nt
  s_add_u32 s57, s57, 0x1000
  s_and_b32 s57, s57, 0x1F000
  buffer_load_dwordx4 v[152:155], v1, s[40:43], s57 offen nt
  s_add_u32 s57, s57, 0x1000
  s_and_b32 s57, s57, 0x1F000
  buffer_load_dwordx4 v[156:159], v1, s[40:43], s57 offen nt
  s_add_u32 s57, s57, 0x1000
  s_and_b32 s57, s57, 0x1F000
  buffer_load_dwordx4 v[160:163], v1, s[40:43], s57 offen nt
  s_add_u32 s57, s57, 0x1000
  s_and_b32 s57, s57, 0x1F000
  buffer_load_dwordx4 v[164:167], v1, s[40:43], s57 offen nt
  v_lshrrev_b32 v2, 4, v0
  v_and_b32 v3, 15, v0
  s_waitcnt lgkmcnt(0)
  s_add_u32 s36, s39, 0x9E3779B9
  s_mul_i32 s36, s36, 0x01010101
  s_and_b32 s32, s36, 0xff
  s_bfe_u32 s33, s36, 0x80008
  s_bfe_u32 s34, s36, 0x80010
  s_lshr_b32 s35, s36, 24
  s_and_b32 s37, s36, 0xffff
  s_lshr_b32 s38, s36, 16
  s_mov_b32 s44, s26
  s_mov_b32 s45, s27
  s_mov_b32 s46, 2097152
  s_mov_b32 s47, 0x00020000
  s_and_b32 s59, s3, 3
  s_mul_i32 s57, s59, 320
  v_mul_u32_u24 v1, 80, v2
  v_add_u32 v1, s57, v1
  v_mov_b32 v4, 0
  s_barrier
  ds_read_b128 v[8:11], v1 offset:768
  ds_read_b128 v[12:15], v1 offset:784
  ds_read_b128 v[16:19], v1 offset:800
  ds_read_b128 v[20:23], v1 offset:816
  ds_read_b128 v[24:27], v4 offset:512
  ds_read_b128 v[28:31], v4 offset:528
  s_waitcnt lgkmcnt(0)
  v_max_f32 v4, v24, v26
  v_max_f32 v5, v28, v30
  v_max_f32 v4, v4, v5
  v_sub_f32 v32, v24, v4
  v_sub_f32 v33, v26, v4
  v_sub_f32 v34, v28, v4
  v_sub_f32 v35, v30, v4
  v_mul_f32 v32, 1069066811, v32
  v_mul_f32 v33, 1069066811, v33
  v_mul_f32 v34, 1069066811, v34
  v_mul_f32 v35, 1069066811, v35
  v_exp_f32 v32, v32
  v_exp_f32 v33, v33
  v_exp_f32 v34, v34
  v_exp_f32 v35, v35
  v_mul_f32 v5, v32, v25
  v_fmac_f32 v5, v33, v27
  v_fmac_f32 v5, v34, v29
  v_fmac_f32 v5, v35, v31
  v_readfirstlane_b32 s98, v32
  v_readfirstlane_b32 s99, v33
  v_readfirstlane_b32 s100, v34
  v_readfirstlane_b32 s101, v35
  v_mov_b32 v6, s36
  v_mov_b32 v7, s36
  s_waitcnt vmcnt(30)
  v_perm_b32 v32, v44, v40, s66
  v_perm_b32 v33, v44, v40, s67
  v_perm_b32 v34, v45, v41, s66
  v_perm_b32 v35, v45, v41, s67
  v_perm_b32 v36, v46, v42, s66
  v_perm_b32 v37, v46, v42, s67
  v_perm_b32 v38, v47, v43, s66
  v_perm_b32 v39, v47, v43, s67
  v_dot2_f32_bf16 v24, v32, v8, 0
  v_dot2_f32_bf16 v25, v33, v8, 0
  v_dot2_f32_bf16 v26, v34, v8, 0
  v_dot2_f32_bf16 v27, v35, v8, 0
  v_dot2_f32_bf16 v28, v36, v8, 0
  v_dot2_f32_bf16 v29, v37, v8, 0
  v_dot2_f32_bf16 v30, v38, v8, 0
  v_dot2_f32_bf16 v31, v39, v8, 0
  s_waitcnt vmcnt(28)
  v_perm_b32 v32, v52, v48, s66
  v_perm_b32 v33, v52, v48, s67
  v_perm_b32 v34, v53, v49, s66
  v_perm_b32 v35, v53, v49, s67
  v_perm_b32 v36, v54, v50, s66
  v_perm_b32 v37, v54, v50, s67
  v_perm_b32 v38, v55, v51, s66
  v_perm_b32 v39, v55, v51, s67
  v_dot2_f32_bf16 v24, v32, v9, v24
  v_dot2_f32_bf16 v25, v33, v9, v25
  v_dot2_f32_bf16 v26, v34, v9, v26
  v_dot2_f32_bf16 v27, v35, v9, v27
  v_dot2_f32_bf16 v28, v36, v9, v28
  v_dot2_f32_bf16 v29, v37, v9, v29
  v_dot2_f32_bf16 v30, v38, v9, v30
  v_dot2_f32_bf16 v31, v39, v9, v31
  s_waitcnt vmcnt(26)
  v_perm_b32 v32, v60, v56, s66
  v_perm_b32 v33, v60, v56, s67
  v_perm_b32 v34, v61, v57, s66
  v_perm_b32 v35, v61, v57, s67
  v_perm_b32 v36, v62, v58, s66
  v_perm_b32 v37, v62, v58, s67
  v_perm_b32 v38, v63, v59, s66
  v_perm_b32 v39, v63, v59, s67
  v_dot2_f32_bf16 v24, v32, v10, v24
  v_dot2_f32_bf16 v25, v33, v10, v25
  v_dot2_f32_bf16 v26, v34, v10, v26
  v_dot2_f32_bf16 v27, v35, v10, v27
  v_dot2_f32_bf16 v28, v36, v10, v28
  v_dot2_f32_bf16 v29, v37, v10, v29
  v_dot2_f32_bf16 v30, v38, v10, v30
  v_dot2_f32_bf16 v31, v39, v10, v31
  s_waitcnt vmcnt(24)
  v_perm_b32 v32, v68, v64, s66
  v_perm_b32 v33, v68, v64, s67
  v_perm_b32 v34, v69, v65, s66
  v_perm_b32 v35, v69, v65, s67
  v_perm_b32 v36, v70, v66, s66
  v_perm_b32 v37, v70, v66, s67
  v_perm_b32 v38, v71, v67, s66
  v_perm_b32 v39, v71, v67, s67
  v_dot2_f32_bf16 v24, v32, v11, v24
  v_dot2_f32_bf16 v25, v33, v11, v25
  v_dot2_f32_bf16 v26, v34, v11, v26
  v_dot2_f32_bf16 v27, v35, v11, v27
  v_dot2_f32_bf16 v28, v36, v11, v28
  v_dot2_f32_bf16 v29, v37, v11, v29
  v_dot2_f32_bf16 v30, v38, v11, v30
  v_dot2_f32_bf16 v31, v39, v11, v31
  s_waitcnt vmcnt(22)
  v_perm_b32 v32, v76, v72, s66
  v_perm_b32 v33, v76, v72, s67
  v_perm_b32 v34, v77, v73, s66
  v_perm_b32 v35, v77, v73, s67
  v_perm_b32 v36, v78, v74, s66
  v_perm_b32 v37, v78, v74, s67
  v_perm_b32 v38, v79, v75, s66
  v_perm_b32 v39, v79, v75, s67
  v_dot2_f32_bf16 v24, v32, v12, v24
  v_dot2_f32_bf16 v25, v33, v12, v25
  v_dot2_f32_bf16 v26, v34, v12, v26
  v_dot2_f32_bf16 v27, v35, v12, v27
  v_dot2_f32_bf16 v28, v36, v12, v28
  v_dot2_f32_bf16 v29, v37, v12, v29
  v_dot2_f32_bf16 v30, v38, v12, v30
  v_dot2_f32_bf16 v31, v39, v12, v31
  s_waitcnt vmcnt(20)
  v_perm_b32 v32, v84, v80, s66
  v_perm_b32 v33, v84, v80, s67
  v_perm_b32 v34, v85, v81, s66
  v_perm_b32 v35, v85, v81, s67
  v_perm_b32 v36, v86, v82, s66
  v_perm_b32 v37, v86, v82, s67
  v_perm_b32 v38, v87, v83, s66
  v_perm_b32 v39, v87, v83, s67
  v_dot2_f32_bf16 v24, v32, v13, v24
  v_dot2_f32_bf16 v25, v33, v13, v25
  v_dot2_f32_bf16 v26, v34, v13, v26
  v_dot2_f32_bf16 v27, v35, v13, v27
  v_dot2_f32_bf16 v28, v36, v13, v28
  v_dot2_f32_bf16 v29, v37, v13, v29
  v_dot2_f32_bf16 v30, v38, v13, v30
  v_dot2_f32_bf16 v31, v39, v13, v31
  s_waitcnt vmcnt(18)
  v_perm_b32 v32, v92, v88, s66
  v_perm_b32 v33, v92, v88, s67
  v_perm_b32 v34, v93, v89, s66
  v_perm_b32 v35, v93, v89, s67
  v_perm_b32 v36, v94, v90, s66
  v_perm_b32 v37, v94, v90, s67
  v_perm_b32 v38, v95, v91, s66
  v_perm_b32 v39, v95, v91, s67
  v_dot2_f32_bf16 v24, v32, v14, v24
  v_dot2_f32_bf16 v25, v33, v14, v25
  v_dot2_f32_bf16 v26, v34, v14, v26
  v_dot2_f32_bf16 v27, v35, v14, v27
  v_dot2_f32_bf16 v28, v36, v14, v28
  v_dot2_f32_bf16 v29, v37, v14, v29
  v_dot2_f32_bf16 v30, v38, v14, v30
  v_dot2_f32_bf16 v31, v39, v14, v31
  s_waitcnt vmcnt(16)
  v_perm_b32 v32, v100, v96, s66
  v_perm_b32 v33, v100, v96, s67
  v_perm_b32 v34, v101, v97, s66
  v_perm_b32 v35, v101, v97, s67
  v_perm_b32 v36, v102, v98, s66
  v_perm_b32 v37, v102, v98, s67
  v_perm_b32 v38, v103, v99, s66
  v_perm_b32 v39, v103, v99, s67
  v_dot2_f32_bf16 v24, v32, v15, v24
  v_dot2_f32_bf16 v25, v33, v15, v25
  v_dot2_f32_bf16 v26, v34, v15, v26
  v_dot2_f32_bf16 v27, v35, v15, v27
  v_dot2_f32_bf16 v28, v36, v15, v28
  v_dot2_f32_bf16 v29, v37, v15, v29
  v_dot2_f32_bf16 v30, v38, v15, v30
  v_dot2_f32_bf16 v31, v39, v15, v31
  s_waitcnt vmcnt(14)
  v_perm_b32 v32, v108, v104, s66
  v_perm_b32 v33, v108, v104, s67
  v_perm_b32 v34, v109, v105, s66
  v_perm_b32 v35, v109, v105, s67
  v_perm_b32 v36, v110, v106, s66
  v_perm_b32 v37, v110, v106, s67
  v_perm_b32 v38, v111, v107, s66
  v_perm_b32 v39, v111, v107, s67
  v_dot2_f32_bf16 v24, v32, v16, v24
  v_dot2_f32_bf16 v25, v33, v16, v25
  v_dot2_f32_bf16 v26, v34, v16, v26
  v_dot2_f32_bf16 v27, v35, v16, v27
  v_dot2_f32_bf16 v28, v36, v16, v28
  v_dot2_f32_bf16 v29, v37, v16, v29
  v_dot2_f32_bf16 v30, v38, v16, v30
  v_dot2_f32_bf16 v31, v39, v16, v31
  s_waitcnt vmcnt(12)
  v_perm_b32 v32, v116, v112, s66
  v_perm_b32 v33, v116, v112, s67
  v_perm_b32 v34, v117, v113, s66
  v_perm_b32 v35, v117, v113, s67
  v_perm_b32 v36, v118, v114, s66
  v_perm_b32 v37, v118, v114, s67
  v_perm_b32 v38, v119, v115, s66
  v_perm_b32 v39, v119, v115, s67
  v_dot2_f32_bf16 v24, v32, v17, v24
  v_dot2_f32_bf16 v25, v33, v17, v25
  v_dot2_f32_bf16 v26, v34, v17, v26
  v_dot2_f32_bf16 v27, v35, v17, v27
  v_dot2_f32_bf16 v28, v36, v17, v28
  v_dot2_f32_bf16 v29, v37, v17, v29
  v_dot2_f32_bf16 v30, v38, v17, v30
  v_dot2_f32_bf16 v31, v39, v17, v31
  s_waitcnt vmcnt(10)
  v_perm_b32 v32, v124, v120, s66
  v_perm_b32 v33, v124, v120, s67
  v_perm_b32 v34, v125, v121, s66
  v_perm_b32 v35, v125, v121, s67
  v_perm_b32 v36, v126, v122, s66
  v_perm_b32 v37, v126, v122, s67
  v_perm_b32 v38, v127, v123, s66
  v_perm_b32 v39, v127, v123, s67
  v_dot2_f32_bf16 v24, v32, v18, v24
  v_dot2_f32_bf16 v25, v33, v18, v25
  v_dot2_f32_bf16 v26, v34, v18, v26
  v_dot2_f32_bf16 v27, v35, v18, v27
  v_dot2_f32_bf16 v28, v36, v18, v28
  v_dot2_f32_bf16 v29, v37, v18, v29
  v_dot2_f32_bf16 v30, v38, v18, v30
  v_dot2_f32_bf16 v31, v39, v18, v31
  s_waitcnt vmcnt(8)
  v_perm_b32 v32, v132, v128, s66
  v_perm_b32 v33, v132, v128, s67
  v_perm_b32 v34, v133, v129, s66
  v_perm_b32 v35, v133, v129, s67
  v_perm_b32 v36, v134, v130, s66
  v_perm_b32 v37, v134, v130, s67
  v_perm_b32 v38, v135, v131, s66
  v_perm_b32 v39, v135, v131, s67
  v_dot2_f32_bf16 v24, v32, v19, v24
  v_dot2_f32_bf16 v25, v33, v19, v25
  v_dot2_f32_bf16 v26, v34, v19, v26
  v_dot2_f32_bf16 v27, v35, v19, v27
  v_dot2_f32_bf16 v28, v36, v19, v28
  v_dot2_f32_bf16 v29, v37, v19, v29
  v_dot2_f32_bf16 v30, v38, v19, v30
  v_dot2_f32_bf16 v31, v39, v19, v31
  s_waitcnt vmcnt(6)
  v_perm_b32 v32, v140, v136, s66
  v_perm_b32 v33, v140, v136, s67
  v_perm_b32 v34, v141, v137, s66
  v_perm_b32 v35, v141, v137, s67
  v_perm_b32 v36, v142, v138, s66
  v_perm_b32 v37, v142, v138, s67
  v_perm_b32 v38, v143, v139, s66
  v_perm_b32 v39, v143, v139, s67
  v_dot2_f32_bf16 v24, v32, v20, v24
  v_dot2_f32_bf16 v25, v33, v20, v25
  v_dot2_f32_bf16 v26, v34, v20, v26
  v_dot2_f32_bf16 v27, v35, v20, v27
  v_dot2_f32_bf16 v28, v36, v20, v28
  v_dot2_f32_bf16 v29, v37, v20, v29
  v_dot2_f32_bf16 v30, v38, v20, v30
  v_dot2_f32_bf16 v31, v39, v20, v31
  s_waitcnt vmcnt(4)
  v_perm_b32 v32, v148, v144, s66
  v_perm_b32 v33, v148, v144, s67
  v_perm_b32 v34, v149, v145, s66
  v_perm_b32 v35, v149, v145, s67
  v_perm_b32 v36, v150, v146, s66
  v_perm_b32 v37, v150, v146, s67
  v_perm_b32 v38, v151, v147, s66
  v_perm_b32 v39, v151, v147, s67
  v_dot2_f32_bf16 v24, v32, v21, v24
  v_dot2_f32_bf16 v25, v33, v21, v25
  v_dot2_f32_bf16 v26, v34, v21, v26
  v_dot2_f32_bf16 v27, v35, v21, v27
  v_dot2_f32_bf16 v28, v36, v21, v28
  v_dot2_f32_bf16 v29, v37, v21, v29
  v_dot2_f32_bf16 v30, v38, v21, v30
  v_dot2_f32_bf16 v31, v39, v21, v31
  s_waitcnt vmcnt(2)
  v_perm_b32 v32, v156, v152, s66
  v_perm_b32 v33, v156, v152, s67
  v_perm_b32 v34, v157, v153, s66
  v_perm_b32 v35, v157, v153, s67
  v_perm_b32 v36, v158, v154, s66
  v_perm_b32 v37, v158, v154, s67
  v_perm_b32 v38, v159, v155, s66
  v_perm_b32 v39, v159, v155, s67
  v_dot2_f32_bf16 v24, v32, v22, v24
  v_dot2_f32_bf16 v25, v33, v22, v25
  v_dot2_f32_bf16 v26, v34, v22, v26
  v_dot2_f32_bf16 v27, v35, v22, v27
  v_dot2_f32_bf16 v28, v36, v22, v28
  v_dot2_f32_bf16 v29, v37, v22, v29
  v_dot2_f32_bf16 v30, v38, v22, v30
  v_dot2_f32_bf16 v31, v39, v22, v31
  s_waitcnt vmcnt(0)
  v_perm_b32 v32, v164, v160, s66
  v_perm_b32 v33, v164, v160, s67
  v_perm_b32 v34, v165, v161, s66
  v_perm_b32 v35, v165, v161, s67
  v_perm_b32 v36, v166, v162, s66
  v_perm_b32 v37, v166, v162, s67
  v_perm_b32 v38, v167, v163, s66
  v_perm_b32 v39, v167, v163, s67
  v_dot2_f32_bf16 v24, v32, v23, v24
  v_dot2_f32_bf16 v25, v33, v23, v25
  v_dot2_f32_bf16 v26, v34, v23, v26
  v_dot2_f32_bf16 v27, v35, v23, v27
  v_dot2_f32_bf16 v28, v36, v23, v28
  v_dot2_f32_bf16 v29, v37, v23, v29
  v_dot2_f32_bf16 v30, v38, v23, v30
  v_dot2_f32_bf16 v31, v39, v23, v31
  v_permlane32_swap_b32 v24, v28
  v_permlane32_swap_b32 v25, v29
  v_permlane32_swap_b32 v26, v30
  v_permlane32_swap_b32 v27, v31
  v_add_f32 v24, v24, v28
  v_add_f32 v25, v25, v29
  v_add_f32 v26, v26, v30
  v_add_f32 v27, v27, v31
  s_nop 0
  v_permlane16_swap_b32 v24, v26
  v_permlane16_swap_b32 v25, v27
  v_add_f32 v24, v24, v26
  v_add_f32 v25, v25, v27
  v_lshlrev_b32 v1, 5, v3
  v_lshl_add_u32 v1, v2, 3, v1
  s_and_b32 s59, s3, 3
  s_lshl_b32 s57, s59, 9
  v_add_u32 v1, s57, v1
  ds_write_b64 v1, v[24:25] offset:2048
  v_bfe_u32 v32, v0, 2, 2
  v_lshlrev_b32 v32, 7, v32
  v_and_b32 v33, 3, v0
  v_lshl_add_u32 v32, v33, 5, v32
  v_bfe_u32 v33, v0, 4, 1
  v_lshl_add_u32 v32, v33, 4, v32
  v_lshlrev_b32 v33, 4, v0
  v_mov_b32 v34, 0xff
  s_mul_i32 s70, s28, 5120
  s_lshl_b32 s56, s31, 2
  s_add_u32 s56, s56, s30
  s_mul_i32 s56, s56, 640
  s_add_u32 s70, s70, s56
  s_add_u32 s71, s70, 851968
  s_add_u32 s70, s70, 655360
  v_mov_b32 v35, 0
  v_mov_b32 v36, 1
  s_waitcnt lgkmcnt(0)
  s_mov_b64 exec, 1
  ds_add_u32 v35, v36 offset:8
  s_mov_b64 exec, -1
  s_cmp_lg_u32 s3, 4
  s_cbranch_scc1 L_VEXIT
  s_setprio 3
  s_mov_b32 s58, 200000
L_lw_3:
  ds_read_b32 v37, v35 offset:8
  ds_read_b128 v[8:11], v32 offset:2048
  ds_read_b128 v[12:15], v32 offset:2560
  ds_read_b128 v[16:19], v32 offset:3072
  ds_read_b128 v[20:23], v32 offset:3584
  s_waitcnt lgkmcnt(0)
  v_readfirstlane_b32 s56, v37
  s_cmp_eq_u32 s56, 4
  s_cbranch_scc1 L_lwd_4
  s_sub_u32 s58, s58, 1
  s_cbranch_scc0 L_lw_3
L_lwd_4:
  s_mov_b32 exec_hi, 0
  v_mul_f32 v4, s98, v8
  v_mul_f32 v5, s98, v9
  v_mul_f32 v6, s98, v10
  v_mul_f32 v7, s98, v11
  v_fmac_f32 v4, s99, v12
  v_fmac_f32 v5, s99, v13
  v_fmac_f32 v6, s99, v14
  v_fmac_f32 v7, s99, v15
  v_fmac_f32 v4, s100, v16
  v_fmac_f32 v5, s100, v17
  v_fmac_f32 v6, s100, v18
  v_fmac_f32 v7, s100, v19
  v_fmac_f32 v4, s101, v20
  v_fmac_f32 v5, s101, v21
  v_fmac_f32 v6, s101, v22
  v_fmac_f32 v7, s101, v23
  v_bfi_b32 v4, v34, s32, v4
  v_bfi_b32 v5, v34, s33, v5
  v_bfi_b32 v6, v34, s34, v6
  v_bfi_b32 v7, v34, s35, v7
  s_mov_b32 exec_hi, 0xff
  buffer_store_dwordx4 v[4:7], v33, s[44:47], s70 offen
  buffer_store_dwordx4 v[4:7], v33, s[44:47], s71 offen sc1
  ds_write_b32 v35, v36 offset:12
  s_mov_b64 exec, -1
  s_waitcnt vmcnt(0)
  ds_write_b32 v35, v36 offset:36
  s_barrier
L_VEXIT:
  s_endpgm
L_HELP:
  s_setprio 3
  v_mov_b32 v2, 0
  v_lshlrev_b32 v3, 2, v0
  ds_write_b32 v3, v2
  s_waitcnt lgkmcnt(0)
  s_load_dword s39, s[26:27], 0
  s_mov_b32 s44, s26
  s_mov_b32 s45, s27
  s_mov_b32 s46, 2097152
  s_mov_b32 s47, 0x00020000
  v_lshrrev_b32 v2, 4, v0
  v_and_b32 v3, 15, v0
  s_and_b32 s56, s61, 5
  s_cmp_lg_u32 s3, 8
  s_cbranch_scc1 L_NOT8
  s_cmp_lg_u32 s56, 5
  s_cbranch_scc1 L_S1
  s_branch L_HREST
L_NOT8:
  s_cmp_lg_u32 s3, 11
  s_cbranch_scc1 L_NOT11
  s_cmp_lg_u32 s56, 0
  s_cbranch_scc1 L_HREST
  s_add_u32 s28, s28, 20
  s_branch L_S1
L_NOT11:
  s_cmp_eq_u32 s3, 9
  s_cbranch_scc1 L_QG
L_HREST:
  s_barrier
  s_cmp_lg_u32 s3, 10
  s_cbranch_scc1 L_NOPRE
  s_getpc_b64 s[48:49]
L_PC:
  s_sub_u32 s48, s48, L_PC-sequential_preLN__sliding_block_cached__glu_gated_bilinear__decode_kernel
  s_subb_u32 s49, s49, 0
  s_mov_b32 s50, L_CODE_END-sequential_preLN__sliding_block_cached__glu_gated_bilinear__decode_kernel
  s_mov_b32 s51, 0x00020000
  v_lshlrev_b32 v1, 4, v0
  s_lshl_b32 s56, s60, 10
  buffer_load_dwordx4 v[160:163], v1, s[48:51], s56 offen
L_NOPRE:
  s_waitcnt lgkmcnt(0)
  s_add_u32 s36, s39, 0x9E3779B9
  s_mul_i32 s36, s36, 0x01010101
  s_and_b32 s32, s36, 0xff
  s_bfe_u32 s33, s36, 0x80008
  s_bfe_u32 s34, s36, 0x80010
  s_lshr_b32 s35, s36, 24
  s_and_b32 s37, s36, 0xffff
  s_lshr_b32 s38, s36, 16
  s_branch L_HJOIN
L_S1:
  v_lshrrev_b32 v4, 2, v3
  v_and_b32 v5, 3, v3
  s_mov_b32 s48, s4
  s_mov_b32 s49, s5
  s_mov_b32 s50, 4096
  s_mov_b32 s51, 0x00020000
  s_lshl_b32 s56, s30, 20
  s_lshl_b32 s57, s28, 8
  s_add_u32 s56, s56, s57
  s_lshl_b32 s57, s31, 7
  s_add_u32 s56, s56, s57
  s_add_u32 s52, s10, s56
  s_addc_u32 s53, s11, 0
  s_sub_u32 s54, 0x400000, s56
  s_mov_b32 s55, 0x00020000
  v_lshrrev_b32 v9, 3, v3
  v_and_b32 v10, 7, v3
  v_lshlrev_b32 v8, 16, v2
  v_lshl_add_u32 v8, v9, 18, v8
  v_lshl_add_u32 v8, v10, 4, v8
  s_mov_b32 s56, 0
  buffer_load_dwordx4 v[104:107], v8, s[52:55], s56 offen nt
  s_mov_b32 s56, 8192
  buffer_load_dwordx4 v[108:111], v8, s[52:55], s56 offen nt
  s_mov_b32 s56, 16384
  buffer_load_dwordx4 v[112:115], v8, s[52:55], s56 offen nt
  s_mov_b32 s56, 24576
  buffer_load_dwordx4 v[116:119], v8, s[52:55], s56 offen nt
  s_mov_b32 s56, 32768
  buffer_load_dwordx4 v[120:123], v8, s[52:55], s56 offen nt
  s_mov_b32 s56, 40960
  buffer_load_dwordx4 v[124:127], v8, s[52:55], s56 offen nt
  s_mov_b32 s56, 49152
  buffer_load_dwordx4 v[128:131], v8, s[52:55], s56 offen nt
  s_mov_b32 s56, 57344
  buffer_load_dwordx4 v[132:135], v8, s[52:55], s56 offen nt
  s_mov_b32 s56, 524288
  buffer_load_dwordx4 v[136:139], v8, s[52:55], s56 offen nt
  s_mov_b32 s56, 532480
  buffer_load_dwordx4 v[140:143], v8, s[52:55], s56 offen nt
  s_mov_b32 s56, 540672
  buffer_load_dwordx4 v[144:147], v8, s[52:55], s56 offen nt
  s_mov_b32 s56, 548864
  buffer_load_dwordx4 v[148:151], v8, s[52:55], s56 offen nt
  s_mov_b32 s56, 557056
  buffer_load_dwordx4 v[152:155], v8, s[52:55], s56 offen nt
  s_mov_b32 s56, 565248
  buffer_load_dwordx4 v[156:159], v8, s[52:55], s56 offen nt
  s_mov_b32 s56, 573440
  buffer_load_dwordx4 v[160:163], v8, s[52:55], s56 offen nt
  s_mov_b32 s56, 581632
  buffer_load_dwordx4 v[164:167], v8, s[52:55], s56 offen nt
  v_lshlrev_b32 v6, 10, v4
  v_and_b32 v11, 1, v5
  v_lshl_add_u32 v7, v11, 6, v6
  v_lshl_add_u32 v7, v2, 4, v7
  v_lshl_add_u32 v6, v2, 6, v6
  v_lshl_add_u32 v6, v5, 4, v6
  s_lshl_b32 s59, s30, 8
  buffer_load_dwordx4 v[16:19], v6, s[48:51], 0 offen offset:0
  buffer_load_dwordx4 v[20:23], v6, s[48:51], 0 offen offset:256
  buffer_load_dwordx4 v[24:27], v6, s[48:51], 0 offen offset:512
  buffer_load_dwordx4 v[28:31], v6, s[48:51], 0 offen offset:768
  buffer_load_dwordx4 v[32:35], v7, s[48:51], s59 offen
  buffer_load_dwordx4 v[36:39], v7, s[48:51], s59 offen offset:128
  s_barrier
  s_waitcnt vmcnt(0)
  v_dot2_f32_bf16 v40, v16, s68, 0
  v_dot2_f32_bf16 v41, v17, s68, 0
  v_dot2_f32_bf16 v40, v18, s68, v40
  v_dot2_f32_bf16 v41, v19, s68, v41
  v_dot2_f32_bf16 v40, v20, s68, v40
  v_dot2_f32_bf16 v41, v21, s68, v41
  v_dot2_f32_bf16 v40, v22, s68, v40
  v_dot2_f32_bf16 v41, v23, s68, v41
  v_dot2_f32_bf16 v40, v24, s68, v40
  v_dot2_f32_bf16 v41, v25, s68, v41
  v_dot2_f32_bf16 v40, v26, s68, v40
  v_dot2_f32_bf16 v41, v27, s68, v41
  v_dot2_f32_bf16 v40, v28, s68, v40
  v_dot2_f32_bf16 v41, v29, s68, v41
  v_dot2_f32_bf16 v40, v30, s68, v40
  v_dot2_f32_bf16 v41, v31, s68, v41
  s_nop 2
  v_add_f32 v40, v40, v41
  s_nop 1
  v_add_f32_dpp v40, v40, v40 quad_perm:[1,0,3,2] row_mask:0xf bank_mask:0xf
  s_nop 1
  v_add_f32_dpp v40, v40, v40 quad_perm:[2,3,0,1] row_mask:0xf bank_mask:0xf
  v_mov_b32 v41, v40
  s_nop 1
  v_permlane32_swap_b32 v40, v41
  v_add_f32 v40, v40, v41
  v_mov_b32 v41, v40
  s_nop 1
  v_permlane16_swap_b32 v40, v41
  v_add_f32 v40, v40, v41
  v_mul_f32 v40, 0x3B000000, v40
  v_sub_f32 v42, 0, v40
  v_sub_f32 v43, 0, v40
  v_mov_b32 v46, 0
  v_mov_b32 v47, 0
  v_lshlrev_b32 v44, 16, v16
  v_and_b32 v45, 0xffff0000, v16
  v_pk_add_f32 v[44:45], v[44:45], v[42:43]
  v_pk_fma_f32 v[46:47], v[44:45], v[44:45], v[46:47]
  v_lshlrev_b32 v48, 16, v17
  v_and_b32 v49, 0xffff0000, v17
  v_pk_add_f32 v[48:49], v[48:49], v[42:43]
  v_pk_fma_f32 v[46:47], v[48:49], v[48:49], v[46:47]
  v_lshlrev_b32 v44, 16, v18
  v_and_b32 v45, 0xffff0000, v18
  v_pk_add_f32 v[44:45], v[44:45], v[42:43]
  v_pk_fma_f32 v[46:47], v[44:45], v[44:45], v[46:47]
  v_lshlrev_b32 v48, 16, v19
  v_and_b32 v49, 0xffff0000, v19
  v_pk_add_f32 v[48:49], v[48:49], v[42:43]
  v_pk_fma_f32 v[46:47], v[48:49], v[48:49], v[46:47]
  v_lshlrev_b32 v44, 16, v20
  v_and_b32 v45, 0xffff0000, v20
  v_pk_add_f32 v[44:45], v[44:45], v[42:43]
  v_pk_fma_f32 v[46:47], v[44:45], v[44:45], v[46:47]
  v_lshlrev_b32 v48, 16, v21
  v_and_b32 v49, 0xffff0000, v21
  v_pk_add_f32 v[48:49], v[48:49], v[42:43]
  v_pk_fma_f32 v[46:47], v[48:49], v[48:49], v[46:47]
  v_lshlrev_b32 v44, 16, v22
  v_and_b32 v45, 0xffff0000, v22
  v_pk_add_f32 v[44:45], v[44:45], v[42:43]
  v_pk_fma_f32 v[46:47], v[44:45], v[44:45], v[46:47]
  v_lshlrev_b32 v48, 16, v23
  v_and_b32 v49, 0xffff0000, v23
  v_pk_add_f32 v[48:49], v[48:49], v[42:43]
  v_pk_fma_f32 v[46:47], v[48:49], v[48:49], v[46:47]
  v_lshlrev_b32 v44, 16, v24
  v_and_b32 v45, 0xffff0000, v24
  v_pk_add_f32 v[44:45], v[44:45], v[42:43]
  v_pk_fma_f32 v[46:47], v[44:45], v[44:45], v[46:47]
  v_lshlrev_b32 v48, 16, v25
  v_and_b32 v49, 0xffff0000, v25
  v_pk_add_f32 v[48:49], v[48:49], v[42:43]
  v_pk_fma_f32 v[46:47], v[48:49], v[48:49], v[46:47]
  v_lshlrev_b32 v44, 16, v26
  v_and_b32 v45, 0xffff0000, v26
  v_pk_add_f32 v[44:45], v[44:45], v[42:43]
  v_pk_fma_f32 v[46:47], v[44:45], v[44:45], v[46:47]
  v_lshlrev_b32 v48, 16, v27
  v_and_b32 v49, 0xffff0000, v27
  v_pk_add_f32 v[48:49], v[48:49], v[42:43]
  v_pk_fma_f32 v[46:47], v[48:49], v[48:49], v[46:47]
  v_lshlrev_b32 v44, 16, v28
  v_and_b32 v45, 0xffff0000, v28
  v_pk_add_f32 v[44:45], v[44:45], v[42:43]
  v_pk_fma_f32 v[46:47], v[44:45], v[44:45], v[46:47]
  v_lshlrev_b32 v48, 16, v29
  v_and_b32 v49, 0xffff0000, v29
  v_pk_add_f32 v[48:49], v[48:49], v[42:43]
  v_pk_fma_f32 v[46:47], v[48:49], v[48:49], v[46:47]
  v_lshlrev_b32 v44, 16, v30
  v_and_b32 v45, 0xffff0000, v30
  v_pk_add_f32 v[44:45], v[44:45], v[42:43]
  v_pk_fma_f32 v[46:47], v[44:45], v[44:45], v[46:47]
  v_lshlrev_b32 v48, 16, v31
  v_and_b32 v49, 0xffff0000, v31
  v_pk_add_f32 v[48:49], v[48:49], v[42:43]
  v_pk_fma_f32 v[46:47], v[48:49], v[48:49], v[46:47]
  v_add_f32 v46, v46, v47
  s_nop 1
  v_add_f32_dpp v46, v46, v46 quad_perm:[1,0,3,2] row_mask:0xf bank_mask:0xf
  s_nop 1
  v_add_f32_dpp v46, v46, v46 quad_perm:[2,3,0,1] row_mask:0xf bank_mask:0xf
  v_mov_b32 v47, v46
  s_nop 1
  v_permlane32_swap_b32 v46, v47
  v_add_f32 v46, v46, v47
  v_mov_b32 v47, v46
  s_nop 1
  v_permlane16_swap_b32 v46, v47
  v_add_f32 v46, v46, v47
  v_mul_f32 v46, 0x3B000000, v46
  v_cvt_pk_bf16_f32 v41, v40, v40
  v_and_b32 v41, 0xffff0000, v41
  v_cvt_pk_bf16_f32 v43, v46, v46
  v_and_b32 v43, 0xffff0000, v43
  v_add_f32 v43, 0x3727C5AC, v43
  v_cvt_pk_bf16_f32 v43, v43, v43
  v_and_b32 v43, 0xffff0000, v43
  v_sqrt_f32 v43, v43
  s_nop 0
  v_cvt_pk_bf16_f32 v43, v43, v43
  v_and_b32 v43, 0xffff0000, v43
  v_rcp_f32 v42, v43
  v_lshlrev_b32 v48, 16, v32
  v_and_b32 v49, 0xffff0000, v32
  v_lshlrev_b32 v50, 16, v33
  v_and_b32 v51, 0xffff0000, v33
  v_lshlrev_b32 v52, 16, v34
  v_and_b32 v53, 0xffff0000, v34
  v_lshlrev_b32 v54, 16, v35
  v_and_b32 v55, 0xffff0000, v35
  v_sub_f32 v48, v48, v41
  v_sub_f32 v49, v49, v41
  v_sub_f32 v50, v50, v41
  v_sub_f32 v51, v51, v41
  v_sub_f32 v52, v52, v41
  v_sub_f32 v53, v53, v41
  v_sub_f32 v54, v54, v41
  v_sub_f32 v55, v55, v41
  v_cvt_pk_bf16_f32 v16, v48, v49
  v_cvt_pk_bf16_f32 v17, v50, v51
  v_cvt_pk_bf16_f32 v18, v52, v53
  v_cvt_pk_bf16_f32 v19, v54, v55
  v_lshlrev_b32 v48, 16, v16
  v_and_b32 v49, 0xffff0000, v16
  v_lshlrev_b32 v50, 16, v17
  v_and_b32 v51, 0xffff0000, v17
  v_lshlrev_b32 v52, 16, v18
  v_and_b32 v53, 0xffff0000, v18
  v_lshlrev_b32 v54, 16, v19
  v_and_b32 v55, 0xffff0000, v19
  v_mul_f32 v48, v48, v42
  v_mul_f32 v49, v49, v42
  v_mul_f32 v50, v50, v42
  v_mul_f32 v51, v51, v42
  v_mul_f32 v52, v52, v42
  v_mul_f32 v53, v53, v42
  v_mul_f32 v54, v54, v42
  v_mul_f32 v55, v55, v42
  v_cvt_pk_bf16_f32 v16, v48, v49
  v_cvt_pk_bf16_f32 v17, v50, v51
  v_cvt_pk_bf16_f32 v18, v52, v53
  v_cvt_pk_bf16_f32 v19, v54, v55
  v_lshlrev_b32 v48, 16, v36
  v_and_b32 v49, 0xffff0000, v36
  v_lshlrev_b32 v50, 16, v37
  v_and_b32 v51, 0xffff0000, v37
  v_lshlrev_b32 v52, 16, v38
  v_and_b32 v53, 0xffff0000, v38
  v_lshlrev_b32 v54, 16, v39
  v_and_b32 v55, 0xffff0000, v39
  v_sub_f32 v48, v48, v41
  v_sub_f32 v49, v49, v41
  v_sub_f32 v50, v50, v41
  v_sub_f32 v51, v51, v41
  v_sub_f32 v52, v52, v41
  v_sub_f32 v53, v53, v41
  v_sub_f32 v54, v54, v41
  v_sub_f32 v55, v55, v41
  v_cvt_pk_bf16_f32 v20, v48, v49
  v_cvt_pk_bf16_f32 v21, v50, v51
  v_cvt_pk_bf16_f32 v22, v52, v53
  v_cvt_pk_bf16_f32 v23, v54, v55
  v_lshlrev_b32 v48, 16, v20
  v_and_b32 v49, 0xffff0000, v20
  v_lshlrev_b32 v50, 16, v21
  v_and_b32 v51, 0xffff0000, v21
  v_lshlrev_b32 v52, 16, v22
  v_and_b32 v53, 0xffff0000, v22
  v_lshlrev_b32 v54, 16, v23
  v_and_b32 v55, 0xffff0000, v23
  v_mul_f32 v48, v48, v42
  v_mul_f32 v49, v49, v42
  v_mul_f32 v50, v50, v42
  v_mul_f32 v51, v51, v42
  v_mul_f32 v52, v52, v42
  v_mul_f32 v53, v53, v42
  v_mul_f32 v54, v54, v42
  v_mul_f32 v55, v55, v42
  v_cvt_pk_bf16_f32 v20, v48, v49
  v_cvt_pk_bf16_f32 v21, v50, v51
  v_cvt_pk_bf16_f32 v22, v52, v53
  v_cvt_pk_bf16_f32 v23, v54, v55
  s_waitcnt lgkmcnt(0)
  s_add_u32 s36, s39, 0x9E3779B9
  s_mul_i32 s36, s36, 0x01010101
  s_and_b32 s32, s36, 0xff
  s_bfe_u32 s33, s36, 0x80008
  s_bfe_u32 s34, s36, 0x80010
  s_lshr_b32 s35, s36, 24
  s_and_b32 s37, s36, 0xffff
  s_lshr_b32 s38, s36, 16
  v_mov_b32 v15, 0xff
  v_perm_b32 v72, v108, v104, s66
  v_perm_b32 v73, v116, v112, s66
  v_perm_b32 v74, v124, v120, s66
  v_perm_b32 v75, v132, v128, s66
  v_perm_b32 v76, v108, v104, s67
  v_perm_b32 v77, v116, v112, s67
  v_perm_b32 v78, v124, v120, s67
  v_perm_b32 v79, v132, v128, s67
  v_perm_b32 v80, v109, v105, s66
  v_perm_b32 v81, v117, v113, s66
  v_perm_b32 v82, v125, v121, s66
  v_perm_b32 v83, v133, v129, s66
  v_perm_b32 v84, v109, v105, s67
  v_perm_b32 v85, v117, v113, s67
  v_perm_b32 v86, v125, v121, s67
  v_perm_b32 v87, v133, v129, s67
  v_perm_b32 v88, v110, v106, s66
  v_perm_b32 v89, v118, v114, s66
  v_perm_b32 v90, v126, v122, s66
  v_perm_b32 v91, v134, v130, s66
  v_perm_b32 v92, v110, v106, s67
  v_perm_b32 v93, v118, v114, s67
  v_perm_b32 v94, v126, v122, s67
  v_perm_b32 v95, v134, v130, s67
  v_perm_b32 v96, v111, v107, s66
  v_perm_b32 v97, v119, v115, s66
  v_perm_b32 v98, v127, v123, s66
  v_perm_b32 v99, v135, v131, s66
  v_perm_b32 v100, v111, v107, s67
  v_perm_b32 v101, v119, v115, s67
  v_perm_b32 v102, v127, v123, s67
  v_perm_b32 v103, v135, v131, s67
  v_mfma_f32_16x16x32_bf16 v[40:43], v[16:19], v[72:75], 0
  v_mfma_f32_16x16x32_bf16 v[44:47], v[16:19], v[76:79], 0
  v_mfma_f32_16x16x32_bf16 v[48:51], v[16:19], v[80:83], 0
  v_mfma_f32_16x16x32_bf16 v[52:55], v[16:19], v[84:87], 0
  v_mfma_f32_16x16x32_bf16 v[56:59], v[16:19], v[88:91], 0
  v_mfma_f32_16x16x32_bf16 v[60:63], v[16:19], v[92:95], 0
  v_mfma_f32_16x16x32_bf16 v[64:67], v[16:19], v[96:99], 0
  v_mfma_f32_16x16x32_bf16 v[68:71], v[16:19], v[100:103], 0
  v_perm_b32 v104, v140, v136, s66
  v_perm_b32 v105, v148, v144, s66
  v_perm_b32 v106, v156, v152, s66
  v_perm_b32 v107, v164, v160, s66
  v_perm_b32 v108, v140, v136, s67
  v_perm_b32 v109, v148, v144, s67
  v_perm_b32 v110, v156, v152, s67
  v_perm_b32 v111, v164, v160, s67
  v_perm_b32 v112, v141, v137, s66
  v_perm_b32 v113, v149, v145, s66
  v_perm_b32 v114, v157, v153, s66
  v_perm_b32 v115, v165, v161, s66
  v_perm_b32 v116, v141, v137, s67
  v_perm_b32 v117, v149, v145, s67
  v_perm_b32 v118, v157, v153, s67
  v_perm_b32 v119, v165, v161, s67
  v_perm_b32 v120, v142, v138, s66
  v_perm_b32 v121, v150, v146, s66
  v_perm_b32 v122, v158, v154, s66
  v_perm_b32 v123, v166, v162, s66
  v_perm_b32 v124, v142, v138, s67
  v_perm_b32 v125, v150, v146, s67
  v_perm_b32 v126, v158, v154, s67
  v_perm_b32 v127, v166, v162, s67
  v_perm_b32 v128, v143, v139, s66
  v_perm_b32 v129, v151, v147, s66
  v_perm_b32 v130, v159, v155, s66
  v_perm_b32 v131, v167, v163, s66
  v_perm_b32 v132, v143, v139, s67
  v_perm_b32 v133, v151, v147, s67
  v_perm_b32 v134, v159, v155, s67
  v_perm_b32 v135, v167, v163, s67
  v_mfma_f32_16x16x32_bf16 v[40:43], v[20:23], v[104:107], v[40:43]
  v_mfma_f32_16x16x32_bf16 v[44:47], v[20:23], v[108:111], v[44:47]
  v_mfma_f32_16x16x32_bf16 v[48:51], v[20:23], v[112:115], v[48:51]
  v_mfma_f32_16x16x32_bf16 v[52:55], v[20:23], v[116:119], v[52:55]
  v_mfma_f32_16x16x32_bf16 v[56:59], v[20:23], v[120:123], v[56:59]
  v_mfma_f32_16x16x32_bf16 v[60:63], v[20:23], v[124:127], v[60:63]
  v_mfma_f32_16x16x32_bf16 v[64:67], v[20:23], v[128:131], v[64:67]
  v_mfma_f32_16x16x32_bf16 v[68:71], v[20:23], v[132:135], v[68:71]
  v_lshlrev_b32 v6, 11, v2
  v_lshl_add_u32 v6, v10, 5, v6
  v_lshl_add_u32 v6, v9, 4, v6
  s_lshl_b32 s56, s28, 13
  s_lshl_b32 s57, s29, 8
  s_add_u32 s56, s56, s57
  s_add_u32 s56, s56, 65536
  v_add_f32_dpp v24, v41, v40 row_ror:8 row_mask:0xf bank_mask:0x3
  v_add_f32_dpp v25, v45, v44 row_ror:8 row_mask:0xf bank_mask:0x3
  v_add_f32_dpp v26, v49, v48 row_ror:8 row_mask:0xf bank_mask:0x3
  v_add_f32_dpp v27, v53, v52 row_ror:8 row_mask:0xf bank_mask:0x3
  v_add_f32_dpp v24, v56, v57 row_ror:8 row_mask:0xf bank_mask:0xc
  v_add_f32_dpp v25, v60, v61 row_ror:8 row_mask:0xf bank_mask:0xc
  v_add_f32_dpp v26, v64, v65 row_ror:8 row_mask:0xf bank_mask:0xc
  v_add_f32_dpp v27, v68, v69 row_ror:8 row_mask:0xf bank_mask:0xc
  v_bfi_b32 v24, v15, s32, v24
  v_bfi_b32 v25, v15, s33, v25
  v_bfi_b32 v26, v15, s34, v26
  v_bfi_b32 v27, v15, s35, v27
  buffer_store_dwordx4 v[24:27], v6, s[44:47], s56 offen sc1
  v_mov_b32 v4, 0
  v_mov_b32 v5, 1
  ds_write_b32 v4, v5 offset:4
  s_branch L_HJOIN
L_QG:
  s_barrier
  s_waitcnt lgkmcnt(0)
  s_add_u32 s36, s39, 0x9E3779B9
  s_mul_i32 s36, s36, 0x01010101
  s_and_b32 s32, s36, 0xff
  s_bfe_u32 s33, s36, 0x80008
  s_bfe_u32 s34, s36, 0x80010
  s_lshr_b32 s35, s36, 24
  s_and_b32 s37, s36, 0xffff
  s_lshr_b32 s38, s36, 16
  v_lshlrev_b32 v6, 4, v0
  s_lshl_b32 s70, s28, 13
  s_lshl_b32 s57, s30, 11
  s_add_u32 s70, s70, s57
  s_add_u32 s70, s70, 65536
  v_and_b32 v7, 31, v0
  v_lshlrev_b32 v7, 3, v7
  v_lshrrev_b32 v8, 5, v0
  v_lshl_add_u32 v7, v8, 2, v7
  v_mov_b32 v4, 0
  s_mov_b32 s58, 200000
L_lw_5:
  ds_read_b32 v8, v4 offset:16
  s_waitcnt lgkmcnt(0)
  v_readfirstlane_b32 s56, v8
  s_cmp_eq_u32 s56, 4
  s_cbranch_scc1 L_lwd_6
  s_sub_u32 s58, s58, 1
  s_cbranch_scc0 L_lw_5
L_lwd_6:
  s_mov_b32 s58, 40000
  buffer_load_dwordx4 v[16:19], v6, s[44:47], s70 offen sc1
  buffer_load_dwordx4 v[20:23], v6, s[44:47], s70 offen offset:1024 sc1
L_pp_7:
  s_waitcnt vmcnt(0)
  v_xor_b32 v16, s32, v16
  v_xor_b32 v17, s33, v17
  v_xor_b32 v18, s34, v18
  v_xor_b32 v19, s35, v19
  v_xor_b32 v20, s32, v20
  v_xor_b32 v21, s33, v21
  v_xor_b32 v22, s34, v22
  v_xor_b32 v23, s35, v23
  v_or3_b32 v12, v16, v17, v18
  v_or3_b32 v12, v12, v19, v20
  v_or3_b32 v12, v12, v21, v22
  v_or_b32 v12, v12, v23
  v_and_b32 v12, 0xff, v12
  v_cmp_ne_u32 vcc, 0, v12
  s_cbranch_vccz L_ppd_8
  buffer_load_dwordx4 v[16:19], v6, s[44:47], s70 offen sc1
  buffer_load_dwordx4 v[20:23], v6, s[44:47], s70 offen offset:1024 sc1
  s_sub_u32 s58, s58, 1
  s_cbranch_scc0 L_pp_7
L_ppd_8:
  v_pk_add_f32 v[16:17], v[16:17], v[20:21]
  v_pk_add_f32 v[18:19], v[18:19], v[22:23]
  s_nop 1
  v_permlane32_swap_b32 v16, v18
  v_permlane32_swap_b32 v17, v19
  v_add_f32 v16, v16, v18
  v_add_f32 v17, v17, v19
  v_cvt_pk_bf16_f32 v13, v16, v17
L_QGD:
  v_mov_b32 v8, 0
  v_mov_b32 v9, 1
  ds_write_b32 v7, v13 offset:256
  ds_write_b32 v8, v9 offset:0
  s_waitcnt vmcnt(0)
L_HJOIN:
  v_mov_b32 v4, 0
  s_cmp_lg_u32 s60, 15
  s_cbranch_scc1 L_HJ2
  s_cmp_ge_u32 s3, 10
  s_cbranch_scc1 L_PZ
L_HJ2:
  s_cmp_lg_u32 s3, 10
  s_cbranch_scc1 L_TKWAIT
  s_mov_b32 s58, 200000
L_lw_11:
  ds_read_b32 v20, v4 offset:32
  s_waitcnt lgkmcnt(0)
  v_readfirstlane_b32 s56, v20
  s_cmp_eq_u32 s56, 4
  s_cbranch_scc1 L_lwd_12
  s_sub_u32 s58, s58, 1
  s_cbranch_scc0 L_lw_11
L_lwd_12:
  s_mov_b32 s48, s24
  s_mov_b32 s49, s25
  s_mov_b32 s50, 256
  s_mov_b32 s51, 0x00020000
  s_and_b32 s56, s2, 7
  s_lshl_b32 s56, s56, 5
  v_mov_b32 v20, 1
  s_mov_b64 exec, 1
  buffer_atomic_add v20, v4, s[48:51], s56 offen sc0 sc1
  s_waitcnt vmcnt(0)
  v_add_u32 v20, 1, v20
  ds_write_b32 v4, v20 offset:28
  s_mov_b64 exec, -1
L_TKWAIT:
  s_mov_b32 s58, 200000
L_tkw_9:
  ds_read_b32 v20, v4 offset:28
  s_waitcnt lgkmcnt(0)
  v_readfirstlane_b32 s56, v20
  s_cmp_lg_u32 s56, 0
  s_cbranch_scc1 L_tkd_10
  s_sub_u32 s58, s58, 1
  s_cbranch_scc0 L_tkw_9
L_tkd_10:
  s_sub_u32 s56, s56, 1
  s_and_b32 s56, s56, 31
  s_cmp_eq_u32 s61, 3
  s_mov_b32 s0, 0x654210b3
  s_mov_b32 s1, 0xfedca987
  s_mov_b32 s70, 0x76543210
  s_cselect_b32 s70, 0x3210edcb, s70
  s_mov_b32 s71, 0xfedcba98
  s_cselect_b32 s71, 0xfa987654, s71
  s_cmp_ge_u32 s56, 16
  s_cselect_b32 s0, s70, s0
  s_cselect_b32 s1, s71, s1
  s_and_b32 s57, s56, 15
  s_lshl_b32 s57, s57, 2
  s_lshr_b64 s[0:1], s[0:1], s57
  s_and_b32 s0, s0, 15
  s_lshr_b32 s24, s60, 3
  s_lshr_b32 s57, 0xffff, s56
  s_and_b32 s57, s57, 1
  s_lshl_b32 s57, s57, 4
  s_or_b32 s60, s0, s57
  v_lshrrev_b32 v6, 2, v3
  v_and_b32 v7, 3, v3
  v_mov_b32 v4, 0
  s_and_b32 s59, s3, 3
  s_mov_b32 s96, 0x000F000F
  s_mov_b32 s97, 0x000F000F
  s_cmp_lt_u32 s60, 11
  s_cbranch_scc1 L_FSTAGE
  s_cmp_lt_u32 s60, 15
  s_cbranch_scc1 L_RSTAGE
  s_cmp_eq_u32 s60, 15
  s_cbranch_scc1 L_WEXIT
  s_sub_u32 s69, s60, 16
  s_lshr_b32 s56, s69, 3
  s_lshl_b32 s56, s56, 1
  s_lshr_b32 s57, s59, 1
  s_add_u32 s56, s56, s57
  s_lshl_b32 s57, s61, 2
  s_add_u32 s56, s56, s57
  s_mul_i32 s70, s56, 5120
  s_and_b32 s57, s59, 1
  s_lshl_b32 s71, s57, 7
  s_add_u32 s70, s70, s71
  s_add_u32 s70, s70, 655360
  s_lshl_b32 s56, s56, 17
  s_lshl_b32 s57, s57, 16
  s_add_u32 s56, s56, s57
  s_and_b32 s57, s69, 7
  s_lshl_b32 s57, s57, 7
  s_add_u32 s56, s56, s57
  s_add_u32 s48, s12, s56
  s_addc_u32 s49, s13, 0
  s_sub_u32 s50, 0x400000, s56
  s_mov_b32 s51, 0x00020000
  v_lshrrev_b32 v9, 3, v3
  v_and_b32 v10, 7, v3
  v_lshlrev_b32 v8, 15, v9
  v_lshl_add_u32 v8, v2, 13, v8
  v_lshl_add_u32 v8, v10, 4, v8
  v_lshlrev_b32 v17, 8, v2
  v_lshl_add_u32 v17, v10, 5, v17
  v_lshl_add_u32 v17, v9, 4, v17
  s_lshl_b32 s56, s59, 10
  v_add_u32 v17, s56, v17
  s_movk_i32 s0, 640
  v_mul_lo_u32 v9, v6, s0
  v_and_b32 v13, 1, v7
  v_mul_u32_u24 v10, 2560, v13
  v_add_u32 v10, v10, v9
  s_and_b32 s57, s59, 1
  s_lshl_b32 s57, s57, 7
  v_subrev_u32 v10, s57, v10
  v_add_u32 v10, 512, v10
  v_lshl_add_u32 v9, v13, 6, v9
  v_lshl_add_u32 v9, v2, 4, v9
  s_mov_b32 s62, 0xAAAAAAAA
  s_mov_b32 s63, 0xAAAAAAAA
  s_and_b32 s71, s69, 7
  s_lshl_b32 s71, s71, 2
  s_lshr_b32 s56, s69, 3
  s_lshl_b32 s56, s56, 1
  s_add_u32 s71, s71, s56
  s_add_u32 s71, s71, s59
  s_and_b32 s71, s71, 31
  s_mov_b32 s52, s4
  s_mov_b32 s53, s5
  s_mov_b32 s54, 4096
  s_mov_b32 s55, 0x00020000
  v_lshlrev_b32 v11, 10, v6
  v_lshl_add_u32 v11, v7, 3, v11
  v_lshrrev_b32 v12, 1, v2
  v_lshl_add_u32 v11, v12, 2, v11
  s_lshl_b32 s56, s71, 5
  buffer_load_dword v14, v11, s[52:55], s56 offen
  v_mov_b32 v15, 0xff
  v_lshlrev_b32 v16, 8, v6
  v_lshl_add_u32 v16, v2, 6, v16
  v_lshl_add_u32 v16, v7, 4, v16
  v_lshlrev_b32 v19, 4, v3
  v_lshl_add_u32 v19, v2, 12, v19
  s_and_b32 s99, s69, 7
  s_lshl_b32 s99, s99, 14
  s_lshl_b32 s57, s61, 9
  s_add_u32 s99, s99, s57
  s_lshr_b32 s57, s69, 3
  s_lshl_b32 s57, s57, 8
  s_add_u32 s99, s99, s57
  s_add_u32 s99, s99, 1048576
  s_barrier
  s_mov_b32 s56, 0
  buffer_load_dwordx4 v[136:139], v8, s[48:51], s56 offen offset:0 nt
  buffer_load_dwordx4 v[140:143], v8, s[48:51], s56 offen offset:1024 nt
  buffer_load_dwordx4 v[144:147], v8, s[48:51], s56 offen offset:2048 nt
  buffer_load_dwordx4 v[148:151], v8, s[48:51], s56 offen offset:3072 nt
  s_mov_b32 s56, 4096
  buffer_load_dwordx4 v[152:155], v8, s[48:51], s56 offen offset:0 nt
  buffer_load_dwordx4 v[156:159], v8, s[48:51], s56 offen offset:1024 nt
  buffer_load_dwordx4 v[160:163], v8, s[48:51], s56 offen offset:2048 nt
  buffer_load_dwordx4 v[164:167], v8, s[48:51], s56 offen offset:3072 nt
  s_mov_b32 s58, 200000
L_lw_13:
  ds_read_b32 v20, v4 offset:12
  s_waitcnt lgkmcnt(0)
  v_readfirstlane_b32 s56, v20
  s_cmp_eq_u32 s56, 1
  s_cbranch_scc1 L_lwd_14
  s_sub_u32 s58, s58, 1
  s_cbranch_scc0 L_lw_13
L_lwd_14:
  s_mov_b32 s58, 40000
  buffer_load_dwordx4 v[24:27], v9, s[44:47], s70 offen offset:0 sc1
  buffer_load_dwordx4 v[28:31], v9, s[44:47], s70 offen offset:256 sc1
  buffer_load_dwordx4 v[32:35], v9, s[44:47], s70 offen offset:2560 sc1
  buffer_load_dwordx4 v[36:39], v9, s[44:47], s70 offen offset:2816 sc1
  buffer_load_dwordx4 v[40:43], v10, s[44:47], s70 offen sc1
  s_waitcnt vmcnt(5)
  v_perm_b32 v104, v140, v136, s66
  v_perm_b32 v105, v148, v144, s66
  v_perm_b32 v106, v156, v152, s66
  v_perm_b32 v107, v164, v160, s66
  v_perm_b32 v108, v140, v136, s67
  v_perm_b32 v109, v148, v144, s67
  v_perm_b32 v110, v156, v152, s67
  v_perm_b32 v111, v164, v160, s67
  v_perm_b32 v112, v141, v137, s66
  v_perm_b32 v113, v149, v145, s66
  v_perm_b32 v114, v157, v153, s66
  v_perm_b32 v115, v165, v161, s66
  v_perm_b32 v116, v141, v137, s67
  v_perm_b32 v117, v149, v145, s67
  v_perm_b32 v118, v157, v153, s67
  v_perm_b32 v119, v165, v161, s67
  v_perm_b32 v120, v142, v138, s66
  v_perm_b32 v121, v150, v146, s66
  v_perm_b32 v122, v158, v154, s66
  v_perm_b32 v123, v166, v162, s66
  v_perm_b32 v124, v142, v138, s67
  v_perm_b32 v125, v150, v146, s67
  v_perm_b32 v126, v158, v154, s67
  v_perm_b32 v127, v166, v162, s67
  v_perm_b32 v128, v143, v139, s66
  v_perm_b32 v129, v151, v147, s66
  v_perm_b32 v130, v159, v155, s66
  v_perm_b32 v131, v167, v163, s66
  v_perm_b32 v132, v143, v139, s67
  v_perm_b32 v133, v151, v147, s67
  v_perm_b32 v134, v159, v155, s67
  v_perm_b32 v135, v167, v163, s67
  s_waitcnt vmcnt(0)
  v_xor_b32 v24, s32, v24
  v_xor_b32 v25, s33, v25
  v_xor_b32 v26, s34, v26
  v_xor_b32 v27, s35, v27
  v_xor_b32 v28, s32, v28
  v_xor_b32 v29, s33, v29
  v_xor_b32 v30, s34, v30
  v_xor_b32 v31, s35, v31
  v_xor_b32 v32, s32, v32
  v_xor_b32 v33, s33, v33
  v_xor_b32 v34, s34, v34
  v_xor_b32 v35, s35, v35
  v_xor_b32 v36, s32, v36
  v_xor_b32 v37, s33, v37
  v_xor_b32 v38, s34, v38
  v_xor_b32 v39, s35, v39
  v_or3_b32 v20, v24, v25, v26
  v_or3_b32 v20, v20, v27, v28
  v_or3_b32 v20, v20, v29, v30
  v_or3_b32 v20, v20, v31, v32
  v_or3_b32 v20, v20, v33, v34
  v_or3_b32 v20, v20, v35, v36
  v_or3_b32 v20, v20, v37, v38
  v_or_b32 v20, v20, v39
  v_and_b32 v20, 0xff, v20
  v_xor_b32 v21, s36, v42
  v_bitop3_b32 v20, v20, v43, s36 bitop3:0xf6
  v_or_b32 v20, v20, v21
  v_cmp_ne_u32 vcc, 0, v20
  s_cbranch_vccz L_gpd_16
L_gp_15:
  buffer_load_dwordx4 v[24:27], v9, s[44:47], s70 offen offset:0 sc1
  buffer_load_dwordx4 v[28:31], v9, s[44:47], s70 offen offset:256 sc1
  buffer_load_dwordx4 v[32:35], v9, s[44:47], s70 offen offset:2560 sc1
  buffer_load_dwordx4 v[36:39], v9, s[44:47], s70 offen offset:2816 sc1
  buffer_load_dwordx4 v[40:43], v10, s[44:47], s70 offen sc1
  s_waitcnt vmcnt(0)
  v_xor_b32 v24, s32, v24
  v_xor_b32 v25, s33, v25
  v_xor_b32 v26, s34, v26
  v_xor_b32 v27, s35, v27
  v_xor_b32 v28, s32, v28
  v_xor_b32 v29, s33, v29
  v_xor_b32 v30, s34, v30
  v_xor_b32 v31, s35, v31
  v_xor_b32 v32, s32, v32
  v_xor_b32 v33, s33, v33
  v_xor_b32 v34, s34, v34
  v_xor_b32 v35, s35, v35
  v_xor_b32 v36, s32, v36
  v_xor_b32 v37, s33, v37
  v_xor_b32 v38, s34, v38
  v_xor_b32 v39, s35, v39
  v_or3_b32 v20, v24, v25, v26
  v_or3_b32 v20, v20, v27, v28
  v_or3_b32 v20, v20, v29, v30
  v_or3_b32 v20, v20, v31, v32
  v_or3_b32 v20, v20, v33, v34
  v_or3_b32 v20, v20, v35, v36
  v_or3_b32 v20, v20, v37, v38
  v_or_b32 v20, v20, v39
  v_and_b32 v20, 0xff, v20
  v_xor_b32 v21, s36, v42
  v_bitop3_b32 v20, v20, v43, s36 bitop3:0xf6
  v_or_b32 v20, v20, v21
  v_cmp_ne_u32 vcc, 0, v20
  s_cbranch_vccz L_gpd_16
  s_sub_u32 s58, s58, 1
  s_cmp_lg_u32 s58, 39936
  s_cbranch_scc1 L_gpk_17
  s_add_u32 s70, s70, 196608
L_gpk_17:
  s_cmp_lg_u32 s58, 0
  s_cbranch_scc1 L_gp_15
L_gpd_16:
  v_mov_b32_dpp v44, v40 quad_perm:[1,0,3,2] row_mask:0xf bank_mask:0xf
  v_mov_b32_dpp v45, v41 quad_perm:[1,0,3,2] row_mask:0xf bank_mask:0xf
  v_max_f32 v46, v40, v44
  v_sub_f32 v47, v40, v46
  v_sub_f32 v48, v44, v46
  v_mul_f32 v47, 1069066811, v47
  v_mul_f32 v48, 1069066811, v48
  v_exp_f32 v47, v47
  v_exp_f32 v48, v48
  v_mul_f32 v49, v47, v41
  v_fmac_f32 v49, v48, v45
  v_rcp_f32 v49, v49
  v_cndmask_b32_e64 v50, v47, v48, s[62:63]
  v_cndmask_b32_e64 v51, v48, v47, s[62:63]
  v_mul_f32 v50, v50, v49
  v_mul_f32 v51, v51, v49
  v_mul_f32 v24, v50, v24
  v_mul_f32 v25, v50, v25
  v_mul_f32 v26, v50, v26
  v_mul_f32 v27, v50, v27
  v_mul_f32 v28, v50, v28
  v_mul_f32 v29, v50, v29
  v_mul_f32 v30, v50, v30
  v_mul_f32 v31, v50, v31
  v_fmac_f32 v24, v51, v32
  v_fmac_f32 v25, v51, v33
  v_fmac_f32 v26, v51, v34
  v_fmac_f32 v27, v51, v35
  v_fmac_f32 v28, v51, v36
  v_fmac_f32 v29, v51, v37
  v_fmac_f32 v30, v51, v38
  v_fmac_f32 v31, v51, v39
  v_cvt_pk_bf16_f32 v20, v24, v25
  v_cvt_pk_bf16_f32 v21, v26, v27
  v_cvt_pk_bf16_f32 v22, v28, v29
  v_cvt_pk_bf16_f32 v23, v30, v31
  s_nop 1
  v_mfma_f32_16x16x32_bf16 v[56:59], v[20:23], v[104:107], 0
  v_mfma_f32_16x16x32_bf16 v[60:63], v[20:23], v[108:111], 0
  v_mfma_f32_16x16x32_bf16 v[64:67], v[20:23], v[112:115], 0
  v_mfma_f32_16x16x32_bf16 v[68:71], v[20:23], v[116:119], 0
  v_mfma_f32_16x16x32_bf16 v[72:75], v[20:23], v[120:123], 0
  v_mfma_f32_16x16x32_bf16 v[76:79], v[20:23], v[124:127], 0
  v_mfma_f32_16x16x32_bf16 v[80:83], v[20:23], v[128:131], 0
  v_mfma_f32_16x16x32_bf16 v[84:87], v[20:23], v[132:135], 0
  s_nop 0
  v_add_f32_dpp v96, v57, v56 row_ror:8 row_mask:0xf bank_mask:0x3
  v_add_f32_dpp v97, v61, v60 row_ror:8 row_mask:0xf bank_mask:0x3
  v_add_f32_dpp v98, v65, v64 row_ror:8 row_mask:0xf bank_mask:0x3
  v_add_f32_dpp v99, v69, v68 row_ror:8 row_mask:0xf bank_mask:0x3
  v_add_f32_dpp v96, v72, v73 row_ror:8 row_mask:0xf bank_mask:0xc
  v_add_f32_dpp v97, v76, v77 row_ror:8 row_mask:0xf bank_mask:0xc
  v_add_f32_dpp v98, v80, v81 row_ror:8 row_mask:0xf bank_mask:0xc
  v_add_f32_dpp v99, v84, v85 row_ror:8 row_mask:0xf bank_mask:0xc
  ds_write_b128 v17, v[96:99] offset:4096
  s_waitcnt lgkmcnt(0)
  s_barrier
  s_cmp_lt_u32 s59, 2
  s_cbranch_scc1 L_T3
  s_cmp_lg_u32 s59, 2
  s_cbranch_scc1 L_WEXIT
  ds_read_b128 v[64:67], v16 offset:4096
  ds_read_b128 v[68:71], v16 offset:5120
  ds_read_b128 v[72:75], v16 offset:6144
  ds_read_b128 v[76:79], v16 offset:7168
  s_waitcnt lgkmcnt(0)
  v_pk_add_f32 v[64:65], v[64:65], v[68:69]
  v_pk_add_f32 v[66:67], v[66:67], v[70:71]
  v_pk_add_f32 v[72:73], v[72:73], v[76:77]
  v_pk_add_f32 v[74:75], v[74:75], v[78:79]
  v_pk_add_f32 v[64:65], v[64:65], v[72:73]
  v_pk_add_f32 v[66:67], v[66:67], v[74:75]
  v_bfi_b32 v64, v15, s32, v64
  v_bfi_b32 v65, v15, s33, v65
  v_bfi_b32 v66, v15, s34, v66
  v_bfi_b32 v67, v15, s35, v67
  buffer_store_dwordx4 v[64:67], v19, s[44:47], s99 offen sc1
  s_waitcnt vmcnt(0)
  s_barrier
  s_branch L_WEXIT
L_T3:
  v_lshlrev_b32 v11, 4, v0
  s_lshl_b32 s56, s71, 12
  s_add_u32 s70, s56, 1048576
  v_and_b32 v16, 1, v7
  v_lshlrev_b32 v16, 10, v16
  v_lshrrev_b32 v17, 1, v7
  v_lshl_add_u32 v16, v17, 8, v16
  v_lshl_add_u32 v16, v6, 6, v16
  v_lshl_add_u32 v16, v12, 3, v16
  s_lshl_b32 s56, s61, 13
  s_lshr_b32 s57, s71, 3
  s_lshl_b32 s57, s57, 11
  s_add_u32 s56, s56, s57
  s_and_b32 s57, s71, 1
  s_lshl_b32 s57, s57, 9
  s_add_u32 s56, s56, s57
  s_bfe_u32 s57, s71, 0x20001
  s_lshl_b32 s57, s57, 4
  s_add_u32 s56, s56, s57
  s_add_u32 s69, s56, 1179648
  s_add_u32 s71, s56, 1245184
  v_mov_b32 v19, 0xffff
  s_barrier
  s_mov_b32 s58, 40000
  buffer_load_dwordx4 v[24:27], v11, s[44:47], s70 offen offset:0 sc1
  buffer_load_dwordx4 v[28:31], v11, s[44:47], s70 offen offset:1024 sc1
  buffer_load_dwordx4 v[32:35], v11, s[44:47], s70 offen offset:2048 sc1
  buffer_load_dwordx4 v[36:39], v11, s[44:47], s70 offen offset:3072 sc1
L_pp_18:
  s_waitcnt vmcnt(0)
  v_xor_b32 v24, s32, v24
  v_xor_b32 v25, s33, v25
  v_xor_b32 v26, s34, v26
  v_xor_b32 v27, s35, v27
  v_xor_b32 v28, s32, v28
  v_xor_b32 v29, s33, v29
  v_xor_b32 v30, s34, v30
  v_xor_b32 v31, s35, v31
  v_xor_b32 v32, s32, v32
  v_xor_b32 v33, s33, v33
  v_xor_b32 v34, s34, v34
  v_xor_b32 v35, s35, v35
  v_xor_b32 v36, s32, v36
  v_xor_b32 v37, s33, v37
  v_xor_b32 v38, s34, v38
  v_xor_b32 v39, s35, v39
  v_or3_b32 v20, v24, v25, v26
  v_or3_b32 v20, v20, v27, v28
  v_or3_b32 v20, v20, v29, v30
  v_or3_b32 v20, v20, v31, v32
  v_or3_b32 v20, v20, v33, v34
  v_or3_b32 v20, v20, v35, v36
  v_or3_b32 v20, v20, v37, v38
  v_or_b32 v20, v20, v39
  v_and_b32 v20, 0xff, v20
  v_cmp_ne_u32 vcc, 0, v20
  s_cbranch_vccz L_ppd_19
  buffer_load_dwordx4 v[24:27], v11, s[44:47], s70 offen offset:0 sc1
  buffer_load_dwordx4 v[28:31], v11, s[44:47], s70 offen offset:1024 sc1
  buffer_load_dwordx4 v[32:35], v11, s[44:47], s70 offen offset:2048 sc1
  buffer_load_dwordx4 v[36:39], v11, s[44:47], s70 offen offset:3072 sc1
  s_sub_u32 s58, s58, 1
  s_cbranch_scc0 L_pp_18
L_ppd_19:
  v_pk_add_f32 v[64:65], v[24:25], v[28:29]
  v_pk_add_f32 v[66:67], v[26:27], v[30:31]
  v_pk_add_f32 v[68:69], v[32:33], v[36:37]
  v_pk_add_f32 v[70:71], v[34:35], v[38:39]
  v_pk_add_f32 v[64:65], v[64:65], v[68:69]
  v_pk_add_f32 v[66:67], v[66:67], v[70:71]
L_T3D:
  s_nop 1
  v_permlane32_swap_b32 v64, v66
  v_permlane32_swap_b32 v65, v67
  v_add_f32 v64, v64, v66
  v_add_f32 v65, v65, v67
  v_mov_b32 v66, v64
  v_mov_b32 v67, v65
  s_nop 0
  v_permlane16_swap_b32 v64, v66
  v_permlane16_swap_b32 v65, v67
  v_add_f32 v64, v64, v66
  v_add_f32 v65, v65, v67
  v_cvt_pk_bf16_f32 v66, v64, v65
  v_lshlrev_b32 v68, 16, v14
  v_and_b32 v69, 0xffff0000, v14
  v_lshlrev_b32 v64, 16, v66
  v_and_b32 v65, 0xffff0000, v66
  v_add_f32 v64, v64, v68
  v_add_f32 v65, v65, v69
  v_cvt_pk_bf16_f32 v66, v64, v65
  v_lshl_or_b32 v68, v66, 16, s37
  v_bfi_b32 v69, v19, s38, v66
  s_mov_b32 exec_lo, 0xffff
  s_mov_b32 exec_hi, 0xffff
  buffer_store_dwordx2 v[68:69], v16, s[44:47], s69 offen
  buffer_store_dwordx2 v[68:69], v16, s[44:47], s71 offen sc1
  s_mov_b64 exec, -1
  s_branch L_WEXIT
L_FSTAGE:
  s_mul_i32 s69, s61, 11
  s_add_u32 s69, s69, s60
  s_cmp_ge_u32 s69, 86
  s_cbranch_scc1 L_WEXIT
  s_lshl_b32 s56, s69, 5
  s_bitcmp1_b32 s69, 1
  s_cselect_b32 s70, s18, s16
  s_cselect_b32 s71, s19, s17
  s_add_u32 s48, s70, s56
  s_addc_u32 s49, s71, 0
  s_bitcmp1_b32 s69, 1
  s_cselect_b32 s70, s16, s18
  s_cselect_b32 s71, s17, s19
  s_add_u32 s52, s70, s56
  s_addc_u32 s53, s71, 0
  s_sub_u32 s50, 1409024, s56
  s_mov_b32 s51, 0x00020000
  s_sub_u32 s54, 1409024, s56
  s_mov_b32 s55, 0x00020000
  s_and_b32 s57, s69, 1
  s_mul_i32 s57, s57, 11008
  s_mov_b32 s98, s57
  s_add_u32 s99, s57, 5504
  s_sub_u32 s100, 11008, s57
  s_add_u32 s101, s100, 5504
  s_mul_i32 s57, s59, 352256
  s_mov_b32 s56, 88064
  v_mul_lo_u32 v8, v6, s56
  s_mov_b32 s56, 22016
  v_mul_lo_u32 v9, v2, s56
  v_add_u32 v8, v8, v9
  v_lshl_add_u32 v8, v7, 3, v8
  v_add_u32 v8, s57, v8
  v_lshlrev_b32 v9, 4, v0
  s_and_b32 s57, s69, 1
  s_lshl_b32 s57, s57, 10
  s_xor_b32 s56, s57, 1024
  v_add_u32 v12, s56, v9
  v_add_u32 v9, s57, v9
  s_lshl_b32 s70, s61, 13
  s_lshl_b32 s56, s59, 11
  s_add_u32 s70, s70, s56
  s_add_u32 s70, s70, 1179648
  v_lshrrev_b32 v10, 1, v7
  v_lshlrev_b32 v10, 6, v10
  v_lshl_add_u32 v10, v2, 4, v10
  v_and_b32 v11, 1, v7
  v_lshl_add_u32 v10, v11, 3, v10
  s_lshl_b32 s71, s69, 7
  s_add_u32 s71, s71, 1310720
  s_barrier
  s_mov_b32 s58, 200000
L_lw_20:
  ds_read_b32 v20, v4 offset:12
  s_waitcnt lgkmcnt(0)
  v_readfirstlane_b32 s56, v20
  s_cmp_eq_u32 s56, 1
  s_cbranch_scc1 L_lwd_21
  s_sub_u32 s58, s58, 1
  s_cbranch_scc0 L_lw_20
L_lwd_21:
  buffer_load_dwordx2 v[104:105], v8, s[48:51], s98 offen offset:0
  buffer_load_dwordx2 v[106:107], v8, s[48:51], s98 offen offset:2752
  buffer_load_dwordx2 v[108:109], v8, s[48:51], s99 offen offset:0
  buffer_load_dwordx2 v[110:111], v8, s[48:51], s99 offen offset:2752
  buffer_load_dwordx2 v[112:113], v8, s[48:51], s100 offen offset:0
  buffer_load_dwordx2 v[114:115], v8, s[48:51], s100 offen offset:2752
  buffer_load_dwordx2 v[116:117], v8, s[48:51], s101 offen offset:0
  buffer_load_dwordx2 v[118:119], v8, s[48:51], s101 offen offset:2752
  buffer_load_dwordx2 v[120:121], v8, s[52:55], s98 offen offset:0
  buffer_load_dwordx2 v[122:123], v8, s[52:55], s98 offen offset:2752
  buffer_load_dwordx2 v[124:125], v8, s[52:55], s99 offen offset:0
  buffer_load_dwordx2 v[126:127], v8, s[52:55], s99 offen offset:2752
  buffer_load_dwordx2 v[128:129], v8, s[52:55], s100 offen offset:0
  buffer_load_dwordx2 v[130:131], v8, s[52:55], s100 offen offset:2752
  buffer_load_dwordx2 v[132:133], v8, s[52:55], s101 offen offset:0
  buffer_load_dwordx2 v[134:135], v8, s[52:55], s101 offen offset:2752
  s_waitcnt vmcnt(0)
  s_mov_b32 s58, 40000
  buffer_load_dwordx4 v[24:27], v9, s[44:47], s70 offen sc1
  buffer_load_dwordx4 v[28:31], v12, s[44:47], s70 offen sc1
  v_perm_b32 v136, v106, v104, s66
  v_perm_b32 v137, v110, v108, s66
  v_perm_b32 v138, v114, v112, s66
  v_perm_b32 v139, v118, v116, s66
  v_perm_b32 v140, v106, v104, s67
  v_perm_b32 v141, v110, v108, s67
  v_perm_b32 v142, v114, v112, s67
  v_perm_b32 v143, v118, v116, s67
  v_perm_b32 v144, v107, v105, s66
  v_perm_b32 v145, v111, v109, s66
  v_perm_b32 v146, v115, v113, s66
  v_perm_b32 v147, v119, v117, s66
  v_perm_b32 v148, v107, v105, s67
  v_perm_b32 v149, v111, v109, s67
  v_perm_b32 v150, v115, v113, s67
  v_perm_b32 v151, v119, v117, s67
  v_perm_b32 v152, v122, v120, s66
  v_perm_b32 v153, v126, v124, s66
  v_perm_b32 v154, v130, v128, s66
  v_perm_b32 v155, v134, v132, s66
  v_perm_b32 v156, v122, v120, s67
  v_perm_b32 v157, v126, v124, s67
  v_perm_b32 v158, v130, v128, s67
  v_perm_b32 v159, v134, v132, s67
  v_perm_b32 v160, v123, v121, s66
  v_perm_b32 v161, v127, v125, s66
  v_perm_b32 v162, v131, v129, s66
  v_perm_b32 v163, v135, v133, s66
  v_perm_b32 v164, v123, v121, s67
  v_perm_b32 v165, v127, v125, s67
  v_perm_b32 v166, v131, v129, s67
  v_perm_b32 v167, v135, v133, s67
  v_mov_b32 v60, s68
  v_mov_b32 v61, s68
  v_mov_b32 v62, s68
  v_mov_b32 v63, s68
  s_nop 1
  v_mfma_f32_16x16x32_bf16 v[64:67], v[60:63], v[136:139], 0
  v_mfma_f32_16x16x32_bf16 v[68:71], v[60:63], v[140:143], 0
  v_mfma_f32_16x16x32_bf16 v[72:75], v[60:63], v[144:147], 0
  v_mfma_f32_16x16x32_bf16 v[76:79], v[60:63], v[148:151], 0
  v_mfma_f32_16x16x32_bf16 v[80:83], v[60:63], v[152:155], 0
  v_mfma_f32_16x16x32_bf16 v[84:87], v[60:63], v[156:159], 0
  v_mfma_f32_16x16x32_bf16 v[88:91], v[60:63], v[160:163], 0
  v_mfma_f32_16x16x32_bf16 v[92:95], v[60:63], v[164:167], 0
  v_lshlrev_b32 v42, 7, v2
  v_lshl_add_u32 v42, v3, 5, v42
  s_lshl_b32 s56, s59, 9
  v_add_u32 v43, s56, v42
  v_lshlrev_b32 v33, 5, v6
  v_lshrrev_b32 v34, 5, v0
  v_lshl_add_u32 v33, v34, 4, v33
  s_lshl_b32 s56, s59, 2
  v_add_u32 v33, s56, v33
  v_lshlrev_b32 v34, 5, v2
  v_add_f32_dpp v65, v64, v64 row_shl:8 row_mask:0xf bank_mask:0xf
  v_add_f32_dpp v69, v68, v68 row_shl:8 row_mask:0xf bank_mask:0xf
  v_add_f32_dpp v73, v72, v72 row_shl:8 row_mask:0xf bank_mask:0xf
  v_add_f32_dpp v77, v76, v76 row_shl:8 row_mask:0xf bank_mask:0xf
  v_add_f32_dpp v81, v80, v80 row_shl:8 row_mask:0xf bank_mask:0xf
  v_add_f32_dpp v85, v84, v84 row_shl:8 row_mask:0xf bank_mask:0xf
  v_add_f32_dpp v89, v88, v88 row_shl:8 row_mask:0xf bank_mask:0xf
  v_add_f32_dpp v93, v92, v92 row_shl:8 row_mask:0xf bank_mask:0xf
  v_add_f32_dpp v96, v65, v65 row_shl:4 row_mask:0xf bank_mask:0xf
  v_add_f32_dpp v97, v69, v69 row_shl:4 row_mask:0xf bank_mask:0xf
  v_add_f32_dpp v98, v73, v73 row_shl:4 row_mask:0xf bank_mask:0xf
  v_add_f32_dpp v99, v77, v77 row_shl:4 row_mask:0xf bank_mask:0xf
  v_add_f32_dpp v100, v81, v81 row_shl:4 row_mask:0xf bank_mask:0xf
  v_add_f32_dpp v101, v85, v85 row_shl:4 row_mask:0xf bank_mask:0xf
  v_add_f32_dpp v102, v89, v89 row_shl:4 row_mask:0xf bank_mask:0xf
  v_add_f32_dpp v103, v93, v93 row_shl:4 row_mask:0xf bank_mask:0xf
  s_mov_b64 exec, s[96:97]
  ds_write_b128 v43, v[96:99] offset:6144
  ds_write_b128 v43, v[100:103] offset:6160
  s_mov_b64 exec, -1
  s_waitcnt lgkmcnt(0)
  s_barrier
  s_cmp_lg_u32 s59, 0
  s_cbranch_scc1 L_cs_25
  ds_read_b128 v[64:67], v42 offset:6144
  ds_read_b128 v[68:71], v42 offset:6160
  ds_read_b128 v[72:75], v42 offset:6656
  ds_read_b128 v[76:79], v42 offset:6672
  ds_read_b128 v[80:83], v42 offset:7168
  ds_read_b128 v[84:87], v42 offset:7184
  ds_read_b128 v[88:91], v42 offset:7680
  ds_read_b128 v[92:95], v42 offset:7696
  s_waitcnt lgkmcnt(0)
  v_pk_add_f32 v[64:65], v[64:65], v[72:73]
  v_pk_add_f32 v[80:81], v[80:81], v[88:89]
  v_pk_add_f32 v[66:67], v[66:67], v[74:75]
  v_pk_add_f32 v[82:83], v[82:83], v[90:91]
  v_pk_add_f32 v[68:69], v[68:69], v[76:77]
  v_pk_add_f32 v[84:85], v[84:85], v[92:93]
  v_pk_add_f32 v[70:71], v[70:71], v[78:79]
  v_pk_add_f32 v[86:87], v[86:87], v[94:95]
  v_pk_add_f32 v[52:53], v[64:65], v[80:81]
  v_pk_add_f32 v[54:55], v[66:67], v[82:83]
  v_pk_add_f32 v[56:57], v[68:69], v[84:85]
  v_pk_add_f32 v[58:59], v[70:71], v[86:87]
L_cs_25:
  s_waitcnt vmcnt(0)
  v_xor_b32 v32, s37, v24
  v_bitop3_b32 v32, v32, v25, s38 bitop3:0xf6
  v_bitop3_b32 v32, v32, v26, s37 bitop3:0xf6
  v_bitop3_b32 v32, v32, v27, s38 bitop3:0xf6
  v_bitop3_b32 v32, v32, v28, s37 bitop3:0xf6
  v_bitop3_b32 v32, v32, v29, s38 bitop3:0xf6
  v_bitop3_b32 v32, v32, v30, s37 bitop3:0xf6
  v_bitop3_b32 v32, v32, v31, s38 bitop3:0xf6
  v_and_b32 v32, 0xffff, v32
  v_cmp_ne_u32 vcc, 0, v32
  s_cbranch_vccz L_gpd_23
L_gp_22:
  buffer_load_dwordx4 v[24:27], v9, s[44:47], s70 offen sc1
  buffer_load_dwordx4 v[28:31], v12, s[44:47], s70 offen sc1
  s_waitcnt vmcnt(0)
  v_xor_b32 v32, s37, v24
  v_bitop3_b32 v32, v32, v25, s38 bitop3:0xf6
  v_bitop3_b32 v32, v32, v26, s37 bitop3:0xf6
  v_bitop3_b32 v32, v32, v27, s38 bitop3:0xf6
  v_bitop3_b32 v32, v32, v28, s37 bitop3:0xf6
  v_bitop3_b32 v32, v32, v29, s38 bitop3:0xf6
  v_bitop3_b32 v32, v32, v30, s37 bitop3:0xf6
  v_bitop3_b32 v32, v32, v31, s38 bitop3:0xf6
  v_and_b32 v32, 0xffff, v32
  v_cmp_ne_u32 vcc, 0, v32
  s_cbranch_vccz L_gpd_23
  s_sub_u32 s58, s58, 1
  s_cmp_lg_u32 s58, 39936
  s_cbranch_scc1 L_gpk_24
  s_add_u32 s70, s70, 65536
L_gpk_24:
  s_cmp_lg_u32 s58, 0
  s_cbranch_scc1 L_gp_22
L_gpd_23:
  v_perm_b32 v36, v25, v24, s67
  v_perm_b32 v37, v27, v26, s67
  v_perm_b32 v38, v29, v28, s67
  v_perm_b32 v39, v31, v30, s67
  s_nop 1
  v_mfma_f32_16x16x32_bf16 v[64:67], v[36:39], v[136:139], 0
  v_mfma_f32_16x16x32_bf16 v[68:71], v[36:39], v[140:143], 0
  v_mfma_f32_16x16x32_bf16 v[72:75], v[36:39], v[144:147], 0
  v_mfma_f32_16x16x32_bf16 v[76:79], v[36:39], v[148:151], 0
  v_mfma_f32_16x16x32_bf16 v[80:83], v[36:39], v[152:155], 0
  v_mfma_f32_16x16x32_bf16 v[84:87], v[36:39], v[156:159], 0
  v_mfma_f32_16x16x32_bf16 v[88:91], v[36:39], v[160:163], 0
  v_mfma_f32_16x16x32_bf16 v[92:95], v[36:39], v[164:167], 0
  v_dot2_f32_bf16 v40, v36, s68, 0
  v_dot2_f32_bf16 v41, v36, v36, 0
  v_dot2_f32_bf16 v40, v37, s68, v40
  v_dot2_f32_bf16 v41, v37, v37, v41
  v_dot2_f32_bf16 v40, v38, s68, v40
  v_dot2_f32_bf16 v41, v38, v38, v41
  v_dot2_f32_bf16 v40, v39, s68, v40
  v_dot2_f32_bf16 v41, v39, v39, v41
  s_nop 1
  v_add_f32_dpp v40, v40, v40 quad_perm:[1,0,3,2] row_mask:0xf bank_mask:0xf
  v_add_f32_dpp v41, v41, v41 quad_perm:[1,0,3,2] row_mask:0xf bank_mask:0xf
  s_nop 0
  v_add_f32_dpp v40, v40, v40 quad_perm:[2,3,0,1] row_mask:0xf bank_mask:0xf
  v_add_f32_dpp v41, v41, v41 quad_perm:[2,3,0,1] row_mask:0xf bank_mask:0xf
  s_nop 1
  v_permlane32_swap_b32 v40, v41
  v_add_f32 v40, v40, v41
  v_mov_b32 v41, v40
  s_nop 1
  v_permlane16_swap_b32 v40, v41
  v_add_f32 v40, v40, v41
  ds_write_b32 v33, v40 offset:576
  v_add_f32_dpp v96, v65, v64 row_shl:4 row_mask:0xf bank_mask:0xf
  v_add_f32_dpp v97, v69, v68 row_shl:4 row_mask:0xf bank_mask:0xf
  v_add_f32_dpp v98, v73, v72 row_shl:4 row_mask:0xf bank_mask:0xf
  v_add_f32_dpp v99, v77, v76 row_shl:4 row_mask:0xf bank_mask:0xf
  v_add_f32_dpp v100, v81, v80 row_shl:4 row_mask:0xf bank_mask:0xf
  v_add_f32_dpp v101, v85, v84 row_shl:4 row_mask:0xf bank_mask:0xf
  v_add_f32_dpp v102, v89, v88 row_shl:4 row_mask:0xf bank_mask:0xf
  v_add_f32_dpp v103, v93, v92 row_shl:4 row_mask:0xf bank_mask:0xf
  v_add_f32_dpp v96, v66, v96 row_shl:8 row_mask:0xf bank_mask:0xf
  v_add_f32_dpp v97, v70, v97 row_shl:8 row_mask:0xf bank_mask:0xf
  v_add_f32_dpp v98, v74, v98 row_shl:8 row_mask:0xf bank_mask:0xf
  v_add_f32_dpp v99, v78, v99 row_shl:8 row_mask:0xf bank_mask:0xf
  v_add_f32_dpp v100, v82, v100 row_shl:8 row_mask:0xf bank_mask:0xf
  v_add_f32_dpp v101, v86, v101 row_shl:8 row_mask:0xf bank_mask:0xf
  v_add_f32_dpp v102, v90, v102 row_shl:8 row_mask:0xf bank_mask:0xf
  v_add_f32_dpp v103, v94, v103 row_shl:8 row_mask:0xf bank_mask:0xf
  v_add_f32_dpp v96, v67, v96 row_shl:12 row_mask:0xf bank_mask:0xf
  v_add_f32_dpp v97, v71, v97 row_shl:12 row_mask:0xf bank_mask:0xf
  v_add_f32_dpp v98, v75, v98 row_shl:12 row_mask:0xf bank_mask:0xf
  v_add_f32_dpp v99, v79, v99 row_shl:12 row_mask:0xf bank_mask:0xf
  v_add_f32_dpp v100, v83, v100 row_shl:12 row_mask:0xf bank_mask:0xf
  v_add_f32_dpp v101, v87, v101 row_shl:12 row_mask:0xf bank_mask:0xf
  v_add_f32_dpp v102, v91, v102 row_shl:12 row_mask:0xf bank_mask:0xf
  v_add_f32_dpp v103, v95, v103 row_shl:12 row_mask:0xf bank_mask:0xf
  s_mov_b64 exec, s[96:97]
  ds_write_b128 v43, v[96:99] offset:4096
  ds_write_b128 v43, v[100:103] offset:4112
  s_waitcnt lgkmcnt(0)
  s_barrier
  s_cmp_lg_u32 s59, 0
  s_cbranch_scc1 L_WEXIT
  ds_read_b128 v[44:47], v34 offset:576
  ds_read_b128 v[48:51], v34 offset:592
  ds_read_b128 v[64:67], v42 offset:4096
  ds_read_b128 v[68:71], v42 offset:4112
  ds_read_b128 v[72:75], v42 offset:4608
  ds_read_b128 v[76:79], v42 offset:4624
  ds_read_b128 v[80:83], v42 offset:5120
  ds_read_b128 v[84:87], v42 offset:5136
  ds_read_b128 v[88:91], v42 offset:5632
  ds_read_b128 v[92:95], v42 offset:5648
  s_waitcnt lgkmcnt(8)
  v_pk_add_f32 v[44:45], v[44:45], v[46:47]
  v_pk_add_f32 v[48:49], v[48:49], v[50:51]
  v_add_f32 v44, v44, v45
  v_add_f32 v48, v48, v49
  v_mul_f32 v44, 0x3B000000, v44
  v_mul_f32 v48, 0x3B000000, v48
  v_fma_f32 v48, -v44, v44, v48
  v_max_f32 v48, 0, v48
  v_cvt_pk_bf16_f32 v45, v44, v44
  v_and_b32 v45, 0xffff0000, v45
  v_cvt_pk_bf16_f32 v47, v48, v48
  v_and_b32 v47, 0xffff0000, v47
  v_add_f32 v47, 0x3727C5AC, v47
  v_cvt_pk_bf16_f32 v47, v47, v47
  v_and_b32 v47, 0xffff0000, v47
  v_sqrt_f32 v47, v47
  s_nop 0
  v_cvt_pk_bf16_f32 v47, v47, v47
  v_and_b32 v47, 0xffff0000, v47
  v_rcp_f32 v46, v47
  s_waitcnt lgkmcnt(0)
  v_pk_add_f32 v[64:65], v[64:65], v[72:73]
  v_pk_add_f32 v[80:81], v[80:81], v[88:89]
  v_pk_add_f32 v[66:67], v[66:67], v[74:75]
  v_pk_add_f32 v[82:83], v[82:83], v[90:91]
  v_pk_add_f32 v[68:69], v[68:69], v[76:77]
  v_pk_add_f32 v[84:85], v[84:85], v[92:93]
  v_pk_add_f32 v[70:71], v[70:71], v[78:79]
  v_pk_add_f32 v[86:87], v[86:87], v[94:95]
  v_pk_add_f32 v[64:65], v[64:65], v[80:81]
  v_pk_add_f32 v[66:67], v[66:67], v[82:83]
  v_pk_add_f32 v[68:69], v[68:69], v[84:85]
  v_pk_add_f32 v[70:71], v[70:71], v[86:87]
  v_fma_f32 v64, -v45, v52, v64
  v_fma_f32 v65, -v45, v53, v65
  v_fma_f32 v66, -v45, v54, v66
  v_fma_f32 v67, -v45, v55, v67
  v_fma_f32 v68, -v45, v56, v68
  v_fma_f32 v69, -v45, v57, v69
  v_fma_f32 v70, -v45, v58, v70
  v_fma_f32 v71, -v45, v59, v71
  v_mul_f32 v64, v46, v64
  v_mul_f32 v65, v46, v65
  v_mul_f32 v66, v46, v66
  v_mul_f32 v67, v46, v67
  v_mul_f32 v68, v46, v68
  v_mul_f32 v69, v46, v69
  v_mul_f32 v70, v46, v70
  v_mul_f32 v71, v46, v71
  v_cvt_pk_bf16_f32 v72, v64, v65
  v_cvt_pk_bf16_f32 v73, v66, v67
  v_cvt_pk_bf16_f32 v74, v68, v69
  v_cvt_pk_bf16_f32 v75, v70, v71
  v_lshlrev_b32 v64, 16, v72
  v_and_b32 v65, 0xffff0000, v72
  v_lshlrev_b32 v66, 16, v73
  v_and_b32 v67, 0xffff0000, v73
  v_lshlrev_b32 v68, 16, v74
  v_and_b32 v69, 0xffff0000, v74
  v_lshlrev_b32 v70, 16, v75
  v_and_b32 v71, 0xffff0000, v75
  v_mul_f32 v64, v64, v68
  v_mul_f32 v65, v65, v69
  v_mul_f32 v66, v66, v70
  v_mul_f32 v67, v67, v71
  v_cvt_pk_bf16_f32 v72, v64, v65
  v_cvt_pk_bf16_f32 v73, v66, v67
  buffer_store_dwordx2 v[72:73], v10, s[44:47], s71 offen sc1
  s_lshl_b32 s56, s61, 7
  s_lshl_b32 s57, s60, 2
  s_add_u32 s56, s56, s57
  s_add_u32 s56, s56, 1376256
  s_mov_b64 exec, 1
  v_mov_b32 v44, s36
  v_mov_b32 v45, 0
  buffer_store_dword v44, v45, s[44:47], s56 offen
  s_mov_b64 exec, -1
  s_branch L_WEXIT
L_RSTAGE:
  s_lshl_b32 s69, s61, 2
  s_add_u32 s69, s69, s60
  s_sub_u32 s69, s69, 11
  s_lshl_b32 s56, s69, 5
  s_add_u32 s48, s20, s56
  s_addc_u32 s49, s21, 0
  s_sub_u32 s50, 1409024, s56
  s_mov_b32 s51, 0x00020000
  v_lshlrev_b32 v8, 15, v6
  v_lshl_add_u32 v8, v2, 13, v8
  v_lshl_add_u32 v8, v7, 3, v8
  s_lshl_b32 s57, s59, 17
  v_add_u32 v8, s57, v8
  s_sub_u32 s98, s60, 11
  s_cmp_eq_u32 s98, 3
  s_cselect_b32 s98, 0, s98
  s_add_u32 s99, s98, 1
  s_cmp_eq_u32 s99, 3
  s_cselect_b32 s99, 0, s99
  s_add_u32 s100, s99, 1
  s_cmp_eq_u32 s100, 3
  s_cselect_b32 s100, 0, s100
  s_lshl_b32 s57, s100, 19
  v_add_u32 v10, s57, v8
  s_lshl_b32 s57, s99, 19
  v_add_u32 v9, s57, v8
  s_lshl_b32 s57, s98, 19
  v_add_u32 v8, s57, v8
  v_lshrrev_b32 v11, 1, v2
  v_lshl_add_u32 v11, v7, 1, v11
  s_lshl_b32 s57, s59, 3
  v_add_u32 v11, s57, v11
  v_and_b32 v16, 1, v2
  v_lshlrev_b32 v16, 6, v16
  v_lshl_add_u32 v16, v6, 4, v16
  s_lshl_b32 s57, s98, 5
  v_add_u32 v12, s57, v11
  v_min_u32 v12, 85, v12
  v_lshl_add_u32 v12, v12, 7, v16
  s_lshl_b32 s57, s99, 5
  v_add_u32 v13, s57, v11
  v_min_u32 v13, 85, v13
  v_lshl_add_u32 v13, v13, 7, v16
  s_lshl_b32 s57, s100, 5
  v_add_u32 v14, s57, v11
  v_min_u32 v14, 85, v14
  v_lshl_add_u32 v14, v14, 7, v16
  v_and_b32 v17, 1, v7
  v_lshlrev_b32 v17, 10, v17
  v_lshrrev_b32 v18, 1, v7
  v_lshl_add_u32 v17, v18, 8, v17
  v_lshl_add_u32 v17, v2, 6, v17
  s_lshl_b32 s71, s61, 13
  s_lshr_b32 s57, s69, 3
  s_lshl_b32 s57, s57, 11
  s_add_u32 s71, s71, s57
  s_and_b32 s57, s69, 1
  s_lshl_b32 s57, s57, 9
  s_add_u32 s71, s71, s57
  s_bfe_u32 s57, s69, 0x20001
  s_lshl_b32 s57, s57, 4
  s_add_u32 s71, s71, s57
  s_add_u32 s71, s71, 1179648
  s_mov_b32 s70, 1310720
  v_lshlrev_b32 v60, 6, v2
  v_lshl_add_u32 v60, v3, 4, v60
  s_lshl_b32 s56, s59, 8
  v_add_u32 v61, s56, v60
  s_mov_b32 s52, s22
  s_mov_b32 s53, s23
  s_mov_b32 s54, 4096
  s_mov_b32 s55, 0x00020000
  v_lshlrev_b32 v62, 10, v2
  v_lshl_add_u32 v62, v3, 3, v62
  s_waitcnt vmcnt(0)
  s_barrier
  s_mov_b32 s56, 4096
  s_mov_b32 s58, 200000
L_lw_26:
  ds_read_b32 v20, v4 offset:36
  s_waitcnt lgkmcnt(0)
  v_readfirstlane_b32 s56, v20
  s_cmp_eq_u32 s56, 1
  s_cbranch_scc1 L_lwd_27
  s_sub_u32 s58, s58, 1
  s_cbranch_scc0 L_lw_26
L_lwd_27:
  s_mov_b32 s56, 4096
  buffer_load_dwordx2 v[72:73], v8, s[48:51], 0 offen offset:0
  buffer_load_dwordx2 v[74:75], v8, s[48:51], 0 offen offset:1024
  buffer_load_dwordx2 v[76:77], v8, s[48:51], 0 offen offset:2048
  buffer_load_dwordx2 v[78:79], v8, s[48:51], 0 offen offset:3072
  buffer_load_dwordx2 v[80:81], v8, s[48:51], s56 offen offset:0
  buffer_load_dwordx2 v[82:83], v8, s[48:51], s56 offen offset:1024
  buffer_load_dwordx2 v[84:85], v8, s[48:51], s56 offen offset:2048
  buffer_load_dwordx2 v[86:87], v8, s[48:51], s56 offen offset:3072
  buffer_load_dwordx2 v[88:89], v9, s[48:51], 0 offen offset:0
  buffer_load_dwordx2 v[90:91], v9, s[48:51], 0 offen offset:1024
  buffer_load_dwordx2 v[92:93], v9, s[48:51], 0 offen offset:2048
  buffer_load_dwordx2 v[94:95], v9, s[48:51], 0 offen offset:3072
  buffer_load_dwordx2 v[96:97], v9, s[48:51], s56 offen offset:0
  buffer_load_dwordx2 v[98:99], v9, s[48:51], s56 offen offset:1024
  buffer_load_dwordx2 v[100:101], v9, s[48:51], s56 offen offset:2048
  buffer_load_dwordx2 v[102:103], v9, s[48:51], s56 offen offset:3072
  buffer_load_dwordx2 v[104:105], v10, s[48:51], 0 offen offset:0
  buffer_load_dwordx2 v[106:107], v10, s[48:51], 0 offen offset:1024
  buffer_load_dwordx2 v[108:109], v10, s[48:51], 0 offen offset:2048
  buffer_load_dwordx2 v[110:111], v10, s[48:51], 0 offen offset:3072
  buffer_load_dwordx2 v[112:113], v10, s[48:51], s56 offen offset:0
  buffer_load_dwordx2 v[114:115], v10, s[48:51], s56 offen offset:1024
  buffer_load_dwordx2 v[116:117], v10, s[48:51], s56 offen offset:2048
  buffer_load_dwordx2 v[118:119], v10, s[48:51], s56 offen offset:3072
  s_cmp_eq_u32 s61, 7
  s_cselect_b32 s57, 8, 10
  v_min_u32 v41, s57, v0
  v_lshlrev_b32 v41, 2, v41
  s_lshl_b32 s101, s61, 7
  s_add_u32 s101, s101, 1376256
  buffer_load_dword v40, v41, s[44:47], s101 offen sc1
  buffer_load_dwordx4 v[20:23], v17, s[44:47], s71 offen sc1
  s_waitcnt vmcnt(0)
  v_xor_b32 v18, s37, v20
  v_bitop3_b32 v18, v18, v21, s38 bitop3:0xf6
  v_bitop3_b32 v18, v18, v22, s37 bitop3:0xf6
  v_bitop3_b32 v18, v18, v23, s38 bitop3:0xf6
  v_and_b32 v18, 0xffff, v18
  v_cmp_ne_u32 vcc, 0, v18
  v_perm_b32 v120, v74, v72, s66
  v_perm_b32 v121, v78, v76, s66
  v_perm_b32 v122, v82, v80, s66
  v_perm_b32 v123, v86, v84, s66
  v_perm_b32 v124, v74, v72, s67
  v_perm_b32 v125, v78, v76, s67
  v_perm_b32 v126, v82, v80, s67
  v_perm_b32 v127, v86, v84, s67
  v_perm_b32 v128, v75, v73, s66
  v_perm_b32 v129, v79, v77, s66
  v_perm_b32 v130, v83, v81, s66
  v_perm_b32 v131, v87, v85, s66
  v_perm_b32 v132, v75, v73, s67
  v_perm_b32 v133, v79, v77, s67
  v_perm_b32 v134, v83, v81, s67
  v_perm_b32 v135, v87, v85, s67
  v_perm_b32 v136, v90, v88, s66
  v_perm_b32 v137, v94, v92, s66
  v_perm_b32 v138, v98, v96, s66
  v_perm_b32 v139, v102, v100, s66
  v_perm_b32 v140, v90, v88, s67
  v_perm_b32 v141, v94, v92, s67
  v_perm_b32 v142, v98, v96, s67
  v_perm_b32 v143, v102, v100, s67
  v_perm_b32 v144, v91, v89, s66
  v_perm_b32 v145, v95, v93, s66
  v_perm_b32 v146, v99, v97, s66
  v_perm_b32 v147, v103, v101, s66
  v_perm_b32 v148, v91, v89, s67
  v_perm_b32 v149, v95, v93, s67
  v_perm_b32 v150, v99, v97, s67
  v_perm_b32 v151, v103, v101, s67
  v_perm_b32 v152, v106, v104, s66
  v_perm_b32 v153, v110, v108, s66
  v_perm_b32 v154, v114, v112, s66
  v_perm_b32 v155, v118, v116, s66
  v_perm_b32 v156, v106, v104, s67
  v_perm_b32 v157, v110, v108, s67
  v_perm_b32 v158, v114, v112, s67
  v_perm_b32 v159, v118, v116, s67
  v_perm_b32 v160, v107, v105, s66
  v_perm_b32 v161, v111, v109, s66
  v_perm_b32 v162, v115, v113, s66
  v_perm_b32 v163, v119, v117, s66
  v_perm_b32 v164, v107, v105, s67
  v_perm_b32 v165, v111, v109, s67
  v_perm_b32 v166, v115, v113, s67
  v_perm_b32 v167, v119, v117, s67
  s_cbranch_vccz L_rok_31
  s_mov_b32 s58, 40000
L_gp_34:
  buffer_load_dwordx4 v[20:23], v17, s[44:47], s71 offen sc1
  s_waitcnt vmcnt(0)
  v_xor_b32 v18, s37, v20
  v_bitop3_b32 v18, v18, v21, s38 bitop3:0xf6
  v_bitop3_b32 v18, v18, v22, s37 bitop3:0xf6
  v_bitop3_b32 v18, v18, v23, s38 bitop3:0xf6
  v_and_b32 v18, 0xffff, v18
  v_cmp_ne_u32 vcc, 0, v18
  s_cbranch_vccz L_gpd_35
  s_sub_u32 s58, s58, 1
  s_cmp_lg_u32 s58, 39936
  s_cbranch_scc1 L_gpk_36
  s_add_u32 s71, s71, 65536
L_gpk_36:
  s_cmp_lg_u32 s58, 0
  s_cbranch_scc1 L_gp_34
L_gpd_35:
L_rok_31:
  s_mov_b32 s58, 64
L_rtr_32:
  buffer_load_dword v40, v41, s[44:47], s101 offen sc1
  s_waitcnt vmcnt(0)
  v_cmp_ne_u32 vcc, s36, v40
  s_cbranch_vccz L_rtd_33
  s_sub_u32 s58, s58, 1
  s_cbranch_scc0 L_rtr_32
L_rtd_33:
  s_mov_b32 s58, 40000
L_rp_29:
  buffer_load_dwordx4 v[24:27], v12, s[44:47], s70 offen sc1
  buffer_load_dwordx4 v[28:31], v13, s[44:47], s70 offen sc1
  buffer_load_dwordx4 v[32:35], v14, s[44:47], s70 offen sc1
  s_waitcnt vmcnt(0)
  v_max3_u32 v18, v24, v25, v26
  v_max3_u32 v18, v18, v27, v28
  v_max3_u32 v18, v18, v29, v30
  v_max3_u32 v18, v18, v31, v32
  v_max3_u32 v18, v18, v33, v34
  v_max_u32 v18, v18, v35
  v_cmp_eq_u32 vcc, -1, v18
  s_cbranch_vccz L_rpd_30
  s_sub_u32 s58, s58, 1
  s_cbranch_scc0 L_rp_29
L_rpd_30:
  v_mfma_f32_16x16x32_bf16 v[72:75], v[24:27], v[120:123], 0
  v_mfma_f32_16x16x32_bf16 v[76:79], v[24:27], v[124:127], 0
  v_mfma_f32_16x16x32_bf16 v[80:83], v[24:27], v[128:131], 0
  v_mfma_f32_16x16x32_bf16 v[84:87], v[24:27], v[132:135], 0
  v_mfma_f32_16x16x32_bf16 v[72:75], v[28:31], v[136:139], v[72:75]
  v_mfma_f32_16x16x32_bf16 v[76:79], v[28:31], v[140:143], v[76:79]
  v_mfma_f32_16x16x32_bf16 v[80:83], v[28:31], v[144:147], v[80:83]
  v_mfma_f32_16x16x32_bf16 v[84:87], v[28:31], v[148:151], v[84:87]
  v_mfma_f32_16x16x32_bf16 v[72:75], v[32:35], v[152:155], v[72:75]
  v_mfma_f32_16x16x32_bf16 v[76:79], v[32:35], v[156:159], v[76:79]
  v_mfma_f32_16x16x32_bf16 v[80:83], v[32:35], v[160:163], v[80:83]
  v_mfma_f32_16x16x32_bf16 v[84:87], v[32:35], v[164:167], v[84:87]
  s_nop 4
  v_add_f32_dpp v96, v73, v72 row_shl:4 row_mask:0xf bank_mask:0xf
  v_add_f32_dpp v97, v77, v76 row_shl:4 row_mask:0xf bank_mask:0xf
  v_add_f32_dpp v98, v81, v80 row_shl:4 row_mask:0xf bank_mask:0xf
  v_add_f32_dpp v99, v85, v84 row_shl:4 row_mask:0xf bank_mask:0xf
  v_add_f32_dpp v96, v74, v96 row_shl:8 row_mask:0xf bank_mask:0xf
  v_add_f32_dpp v97, v78, v97 row_shl:8 row_mask:0xf bank_mask:0xf
  v_add_f32_dpp v98, v82, v98 row_shl:8 row_mask:0xf bank_mask:0xf
  v_add_f32_dpp v99, v86, v99 row_shl:8 row_mask:0xf bank_mask:0xf
  v_add_f32_dpp v96, v75, v96 row_shl:12 row_mask:0xf bank_mask:0xf
  v_add_f32_dpp v97, v79, v97 row_shl:12 row_mask:0xf bank_mask:0xf
  v_add_f32_dpp v98, v83, v98 row_shl:12 row_mask:0xf bank_mask:0xf
  v_add_f32_dpp v99, v87, v99 row_shl:12 row_mask:0xf bank_mask:0xf
  s_mov_b64 exec, s[96:97]
  ds_write_b128 v61, v[96:99] offset:4096
  s_waitcnt lgkmcnt(0)
  s_barrier
  s_cmp_lg_u32 s59, 0
  s_cbranch_scc1 L_WEXIT
  ds_read_b128 v[100:103], v60 offset:4096
  ds_read_b128 v[104:107], v60 offset:4352
  ds_read_b128 v[108:111], v60 offset:4608
  ds_read_b128 v[112:115], v60 offset:4864
  s_lshl_b32 s56, s69, 5
  v_and_b32 v116, 0xffff0000, v20
  v_and_b32 v117, 0xffff0000, v21
  v_and_b32 v118, 0xffff0000, v22
  v_and_b32 v119, 0xffff0000, v23
  s_waitcnt lgkmcnt(0)
  v_pk_add_f32 v[100:101], v[100:101], v[104:105]
  v_pk_add_f32 v[102:103], v[102:103], v[106:107]
  v_pk_add_f32 v[108:109], v[108:109], v[112:113]
  v_pk_add_f32 v[110:111], v[110:111], v[114:115]
  v_pk_add_f32 v[100:101], v[100:101], v[108:109]
  v_pk_add_f32 v[102:103], v[102:103], v[110:111]
  v_cvt_pk_bf16_f32 v104, v100, v101
  v_cvt_pk_bf16_f32 v105, v102, v103
  v_lshlrev_b32 v100, 16, v104
  v_and_b32 v101, 0xffff0000, v104
  v_lshlrev_b32 v102, 16, v105
  v_and_b32 v103, 0xffff0000, v105
  v_pk_add_f32 v[100:101], v[100:101], v[116:117]
  v_pk_add_f32 v[102:103], v[102:103], v[118:119]
  v_cvt_pk_bf16_f32 v104, v100, v101
  v_cvt_pk_bf16_f32 v105, v102, v103
  buffer_store_dwordx2 v[104:105], v62, s[52:55], s56 offen
  s_cmp_lg_u32 s69, 0
  s_cbranch_scc1 L_RDONE
  s_add_u32 s56, s39, 1
  v_mov_b32 v91, s56
  s_mov_b64 exec, 1
  buffer_store_dword v91, v4, s[44:47], 0 offen
L_RDONE:
L_WEXIT:
  s_mov_b64 exec, -1
  s_endpgm
L_PZ:
  s_cmp_lt_u32 s3, 10
  s_cbranch_scc1 L_WEXIT
  s_mul_i32 s70, s61, 1408
  s_sub_u32 s56, s3, 10
  s_lshl_b32 s56, s56, 10
  s_add_u32 s70, s70, s56
  s_add_u32 s70, s70, 1310720
  v_lshlrev_b32 v8, 4, v0
  v_mov_b32 v20, -1
  v_mov_b32 v21, -1
  v_mov_b32 v22, -1
  v_mov_b32 v23, -1
  s_cmp_eq_u32 s3, 10
  s_cselect_b64 exec, -1, 0xffffff
  buffer_store_dwordx4 v[20:23], v8, s[44:47], s70 offen sc1
  s_waitcnt vmcnt(0)
  s_mov_b64 exec, -1
  s_branch L_HJ2
L_END:
  s_endpgm
L_CODE_END:
.section .rodata,"a"
.p2align 6
.amdhsa_kernel sequential_preLN__sliding_block_cached__glu_gated_bilinear__decode_kernel
  .amdhsa_next_free_vgpr 168
  .amdhsa_next_free_sgpr 102
  .amdhsa_accum_offset 168
  .amdhsa_group_segment_fixed_size 0
  .amdhsa_kernarg_size 96
  .amdhsa_user_sgpr_count 2
  .amdhsa_user_sgpr_kernarg_segment_ptr 1
  .amdhsa_system_sgpr_workgroup_id_x 1
.end_amdhsa_kernel
```
